```python
import torch

def _softmax(x, axis=-1):
    return torch.softmax(x, dim=axis)
def _gelu(x):
    return torch.nn.functional.gelu(x, approximate="tanh")
def _silu(x):
    return torch.nn.functional.silu(x)
def _sigmoid(x):
    return torch.sigmoid(x)
def _layernorm(x, axis=-1, eps=1e-5):
    m = x.mean(dim=axis, keepdim=True)
    v = x.var(dim=axis, keepdim=True, unbiased=False)
    return (x - m) / torch.sqrt(v + eps)
def _scatter_add(tgt, idx, src, axis=0):
    return tgt.clone().index_add_(axis, idx, src)
def _segment_sum(src, seg, n):
    out = torch.zeros((n,) + src.shape[1:], dtype=src.dtype)
    return out.index_add_(0, seg, src)
def _pad(x, pw):
    flat = tuple(v for pair in reversed(pw) for v in pair)
    return torch.nn.functional.pad(x, flat)

kernel_name = 'standalone__weight_only_int_quip__prompt'

def setup_inputs():

    _w = (lambda a: (lambda t: t.to(torch.bfloat16) if t.is_floating_point() else t)(torch.as_tensor(a)))
    B, S, D, F = 1, 2048, 640, 1536
    G = -1 if -1 > 0 else D
    D = (D // G) * G
    ng = D // G
    bits = 8 if 8 > 0 else 4
    qmax = 1 << bits
    qw = torch.randint(0, qmax, (D, F)).to(torch.int32)
    U, _ = (lambda *_a, **_k: torch.linalg.qr(*[torch.as_tensor(_x).float() for _x in _a], **_k))((lambda *s: torch.randn(*s, dtype=torch.bfloat16) * 0.05)(D, D))
    V, _ = (lambda *_a, **_k: torch.linalg.qr(*[torch.as_tensor(_x).float() for _x in _a], **_k))((lambda *s: torch.randn(*s, dtype=torch.bfloat16) * 0.05)(F, F))
    return {
        "x": _w((lambda *s: torch.randn(*s, dtype=torch.bfloat16) * 0.05)(B, S, D)),
        "qw": _w(qw),
        "scales": _w(torch.abs((lambda *s: torch.randn(*s, dtype=torch.bfloat16) * 0.05)(ng, F)) * 0.02 + 0.005),
        "zeros": _w(torch.full((ng, F), qmax / 2.0, dtype=float)),
        "U": _w(U.to(float)),
        "V": _w(V.to(float)),
    }

def reference(x, qw, scales, zeros, U, V):
    B, S, D = x.shape
    ng, F = scales.shape
    G = D // ng
    s = (lambda x, n, axis: torch.repeat_interleave(x, n, dim=axis))(scales, G, axis=0)
    z = (lambda x, n, axis: torch.repeat_interleave(x, n, dim=axis))(zeros, G, axis=0)
    wq = ((lambda x, dt: x.to(dt))(qw, x.dtype) - z) * s
    xr = torch.einsum("bsd,de->bse", x, U)
    h  = torch.einsum("bse,ef->bsf", xr, wq)
    y  = torch.einsum("bsf,fg->bsg", h, V)
    return y
```

```asm
; @launch kernel=p1_kernel grid=(256,1,1) block=(768,1,1) lds=155648
; @launch kernel=p2_kernel grid=(256,1,1) block=(512,1,1) lds=143360
.amdgcn_target "amdgcn-amd-amdhsa--gfx950"
.text
.globl p1_kernel
.globl p2_kernel
.p2align 8
.type p1_kernel,@function
p1_kernel:
    s_cmp_ge_u32 s2, 256
    s_cbranch_scc1 P1_end
    s_load_dwordx16 s[32:47], s[0:1], 0
    s_load_dwordx2 s[48:49], s[0:1], 64
    v_lshrrev_b32 v1, 6, v0
    v_and_b32 v0, 63, v0
    s_and_b32 s4, s2, 7
    s_lshr_b32 s5, s2, 3
    v_readfirstlane_b32 s3, v1
    s_nop 3
    s_cmp_lt_u32 s3, 8
    s_cbranch_scc1 P1_cons
    s_cmp_ge_u32 s5, 30
    s_cbranch_scc1 P1_end
    s_cmp_ge_u32 s5, 20
    s_cbranch_scc1 P1_xl
    s_mul_i32 s7, s5, 52
    s_lshr_b32 s7, s7, 8
    s_mul_i32 s51, s7, 5
    s_sub_u32 s6, s5, s51
    s_and_b32 s51, s4, 1
    s_mul_i32 s51, s51, 5
    s_add_u32 s6, s6, s51
    s_lshr_b32 s51, s4, 1
    s_lshl_b32 s51, s51, 2
    s_add_u32 s7, s7, s51
    s_sub_u32 s50, s3, 8
    v_and_b32 v60, 15, v0
    v_lshrrev_b32 v61, 4, v0
    s_mov_b32 s52, 6144
    v_add_u32 v62, 0, v61
    v_mul_lo_u32 v63, v62, s52
    v_xor_b32 v62, v60, v62
    v_lshl_add_u32 v1, v62, 4, v63
    v_add_u32 v62, 4, v61
    v_mul_lo_u32 v63, v62, s52
    v_xor_b32 v62, v60, v62
    v_lshl_add_u32 v2, v62, 4, v63
    v_subrev_u32 v2, 1024, v2
    v_add_u32 v62, 8, v61
    v_mul_lo_u32 v63, v62, s52
    v_xor_b32 v62, v60, v62
    v_lshl_add_u32 v3, v62, 4, v63
    v_subrev_u32 v3, 2048, v3
    v_add_u32 v62, 12, v61
    v_mul_lo_u32 v63, v62, s52
    v_xor_b32 v62, v60, v62
    v_lshl_add_u32 v4, v62, 4, v63
    v_subrev_u32 v4, 3072, v4
    s_lshl_b32 s28, s6, 6
    s_lshl_b32 s51, s50, 4
    s_add_u32 s28, s28, s51
    s_mul_i32 s28, s28, 6144
    s_lshl_b32 s53, s50, 12
    s_add_u32 s53, s53, 0
    s_mov_b32 s52, 3072
    v_add_u32 v62, 0, v0
    v_mul_u32_u24 v63, 171, v62
    v_lshrrev_b32 v63, 11, v63
    v_mul_u32_u24 v64, 12, v63
    v_sub_u32 v62, v62, v64
    v_lshrrev_b32 v64, 3, v63
    v_and_b32 v64, 1, v64
    v_lshlrev_b32 v64, 1, v64
    v_xor_b32 v62, v62, v64
    v_mul_lo_u32 v63, v63, s52
    v_lshl_add_u32 v5, v62, 4, v63
    v_add_u32 v62, 64, v0
    v_mul_u32_u24 v63, 171, v62
    v_lshrrev_b32 v63, 11, v63
    v_mul_u32_u24 v64, 12, v63
    v_sub_u32 v62, v62, v64
    v_lshrrev_b32 v64, 3, v63
    v_and_b32 v64, 1, v64
    v_lshlrev_b32 v64, 1, v64
    v_xor_b32 v62, v62, v64
    v_mul_lo_u32 v63, v63, s52
    v_lshl_add_u32 v6, v62, 4, v63
    v_subrev_u32 v6, 1024, v6
    v_add_u32 v62, 128, v0
    v_mul_u32_u24 v63, 171, v62
    v_lshrrev_b32 v63, 11, v63
    v_mul_u32_u24 v64, 12, v63
    v_sub_u32 v62, v62, v64
    v_lshrrev_b32 v64, 3, v63
    v_and_b32 v64, 1, v64
    v_lshlrev_b32 v64, 1, v64
    v_xor_b32 v62, v62, v64
    v_mul_lo_u32 v63, v63, s52
    v_lshl_add_u32 v7, v62, 4, v63
    v_subrev_u32 v7, 2048, v7
    s_mul_i32 s27, s50, 49152
    s_mul_i32 s51, s7, 192
    s_add_u32 s27, s27, s51
    s_mul_i32 s54, s50, 3072
    s_add_u32 s54, s54, 16384
    s_waitcnt lgkmcnt(0)
    s_mov_b32 s8, s34
    s_and_b32 s9, s35, 0xffff
    s_mov_b32 s10, 3932160
    s_mov_b32 s11, 0x00020000
    s_mov_b32 s12, s42
    s_and_b32 s13, s43, 0xffff
    s_mov_b32 s14, 4718592
    s_mov_b32 s15, 0x00020000
    s_setprio 1
    s_mov_b32 s29, 0
    s_add_u32 m0, s29, s53
    s_nop 0
    buffer_load_dwordx4 v1, s[8:11], s28 offen lds
    buffer_load_dwordx4 v2, s[8:11], s28 offen offset:1024 lds
    buffer_load_dwordx4 v3, s[8:11], s28 offen offset:2048 lds
    buffer_load_dwordx4 v4, s[8:11], s28 offen offset:3072 lds
    s_add_u32 m0, s29, s54
    s_add_u32 s28, s28, 256
    buffer_load_dwordx4 v5, s[12:15], s27 offen lds
    buffer_load_dwordx4 v6, s[12:15], s27 offen offset:1024 lds
    buffer_load_dwordx4 v7, s[12:15], s27 offen offset:2048 lds
    s_add_u32 s27, s27, 196608
    s_add_u32 s29, s29, 28672
    s_cmp_ge_u32 s29, 143360
    s_cselect_b32 s29, 0, s29
    s_add_u32 m0, s29, s53
    s_nop 0
    buffer_load_dwordx4 v1, s[8:11], s28 offen lds
    buffer_load_dwordx4 v2, s[8:11], s28 offen offset:1024 lds
    buffer_load_dwordx4 v3, s[8:11], s28 offen offset:2048 lds
    buffer_load_dwordx4 v4, s[8:11], s28 offen offset:3072 lds
    s_add_u32 m0, s29, s54
    s_add_u32 s28, s28, 256
    buffer_load_dwordx4 v5, s[12:15], s27 offen lds
    buffer_load_dwordx4 v6, s[12:15], s27 offen offset:1024 lds
    buffer_load_dwordx4 v7, s[12:15], s27 offen offset:2048 lds
    s_add_u32 s27, s27, 196608
    s_add_u32 s29, s29, 28672
    s_cmp_ge_u32 s29, 143360
    s_cselect_b32 s29, 0, s29
    s_mov_b32 s31, 22
TL_ldloop:
    s_waitcnt vmcnt(7)
    s_barrier
    s_add_u32 m0, s29, s53
    s_nop 0
    buffer_load_dwordx4 v1, s[8:11], s28 offen lds
    buffer_load_dwordx4 v2, s[8:11], s28 offen offset:1024 lds
    buffer_load_dwordx4 v3, s[8:11], s28 offen offset:2048 lds
    buffer_load_dwordx4 v4, s[8:11], s28 offen offset:3072 lds
    s_add_u32 m0, s29, s54
    s_add_u32 s28, s28, 256
    buffer_load_dwordx4 v5, s[12:15], s27 offen lds
    buffer_load_dwordx4 v6, s[12:15], s27 offen offset:1024 lds
    buffer_load_dwordx4 v7, s[12:15], s27 offen offset:2048 lds
    s_add_u32 s27, s27, 196608
    s_add_u32 s29, s29, 28672
    s_cmp_ge_u32 s29, 143360
    s_cselect_b32 s29, 0, s29
    s_sub_u32 s31, s31, 1
    s_cmp_lg_u32 s31, 0
    s_cbranch_scc1 TL_ldloop
    s_waitcnt vmcnt(7)
    s_barrier
    s_waitcnt vmcnt(0)
    s_barrier
    s_endpgm
P1_xl:
    s_sub_u32 s5, s5, 20
    s_cmp_ge_u32 s5, 5
    s_cselect_b32 s51, 1, 0
    s_mul_i32 s52, s51, 5
    s_sub_u32 s6, s5, s52
    s_lshl_b32 s7, s4, 1
    s_add_u32 s7, s7, s51
    s_sub_u32 s50, s3, 8
    v_and_b32 v60, 15, v0
    v_lshrrev_b32 v61, 4, v0
    s_mov_b32 s52, 1280
    v_add_u32 v62, 0, v61
    v_mul_lo_u32 v63, v62, s52
    v_or_b32 v62, 0, v61
    v_lshlrev_b32 v62, 1, v62
    v_xor_b32 v62, v60, v62
    v_lshl_add_u32 v1, v62, 4, v63
    v_add_u32 v62, 4, v61
    v_mul_lo_u32 v63, v62, s52
    v_or_b32 v62, 0, v61
    v_lshlrev_b32 v62, 1, v62
    v_xor_b32 v62, v60, v62
    v_lshl_add_u32 v2, v62, 4, v63
    v_subrev_u32 v2, 1024, v2
    v_add_u32 v62, 8, v61
    v_mul_lo_u32 v63, v62, s52
    v_or_b32 v62, 4, v61
    v_lshlrev_b32 v62, 1, v62
    v_xor_b32 v62, v60, v62
    v_lshl_add_u32 v3, v62, 4, v63
    v_subrev_u32 v3, 2048, v3
    v_add_u32 v62, 12, v61
    v_mul_lo_u32 v63, v62, s52
    v_or_b32 v62, 4, v61
    v_lshlrev_b32 v62, 1, v62
    v_xor_b32 v62, v60, v62
    v_lshl_add_u32 v4, v62, 4, v63
    v_subrev_u32 v4, 3072, v4
    s_mul_i32 s28, s50, 20480
    s_lshl_b32 s51, s6, 8
    s_add_u32 s28, s28, s51
    s_lshl_b32 s53, s50, 12
    s_add_u32 s53, s53, 0
    v_lshrrev_b32 v62, 3, v0
    v_add_u32 v62, 0, v62
    v_mul_lo_u32 v63, v62, s52
    v_add_u32 v62, 0, v61
    v_and_b32 v62, 7, v62
    v_and_b32 v64, 7, v0
    v_xor_b32 v62, v64, v62
    v_lshl_add_u32 v5, v62, 4, v63
    v_lshrrev_b32 v62, 3, v0
    v_add_u32 v62, 8, v62
    v_mul_lo_u32 v63, v62, s52
    v_add_u32 v62, 4, v61
    v_and_b32 v62, 7, v62
    v_and_b32 v64, 7, v0
    v_xor_b32 v62, v64, v62
    v_lshl_add_u32 v6, v62, 4, v63
    v_subrev_u32 v6, 1024, v6
    v_lshrrev_b32 v62, 3, v0
    v_add_u32 v62, 16, v62
    v_mul_lo_u32 v63, v62, s52
    v_add_u32 v62, 8, v61
    v_and_b32 v62, 7, v62
    v_and_b32 v64, 7, v0
    v_xor_b32 v62, v64, v62
    v_lshl_add_u32 v7, v62, 4, v63
    v_subrev_u32 v7, 2048, v7
    v_lshrrev_b32 v62, 3, v0
    v_add_u32 v62, 24, v62
    v_mul_lo_u32 v63, v62, s52
    v_add_u32 v62, 12, v61
    v_and_b32 v62, 7, v62
    v_and_b32 v64, 7, v0
    v_xor_b32 v62, v64, v62
    v_lshl_add_u32 v8, v62, 4, v63
    v_subrev_u32 v8, 3072, v8
    s_lshl_b32 s27, s7, 7
    s_lshl_b32 s51, s50, 5
    s_add_u32 s27, s27, s51
    s_mul_i32 s27, s27, 1280
    s_lshl_b32 s54, s50, 12
    s_add_u32 s54, s54, 16384
    s_waitcnt lgkmcnt(0)
    s_mov_b32 s8, s40
    s_and_b32 s9, s41, 0xffff
    s_mov_b32 s10, 819200
    s_mov_b32 s11, 0x00020000
    s_mov_b32 s12, s32
    s_and_b32 s13, s33, 0xffff
    s_mov_b32 s14, 2621440
    s_mov_b32 s15, 0x00020000
    s_setprio 1
    s_mov_b32 s29, 0
    s_add_u32 m0, s29, s53
    s_nop 0
    buffer_load_dwordx4 v1, s[8:11], s28 offen lds
    buffer_load_dwordx4 v2, s[8:11], s28 offen offset:1024 lds
    buffer_load_dwordx4 v3, s[8:11], s28 offen offset:2048 lds
    buffer_load_dwordx4 v4, s[8:11], s28 offen offset:3072 lds
    s_add_u32 m0, s29, s54
    s_add_u32 s28, s28, 81920
    buffer_load_dwordx4 v5, s[12:15], s27 offen lds
    buffer_load_dwordx4 v6, s[12:15], s27 offen offset:1024 lds
    buffer_load_dwordx4 v7, s[12:15], s27 offen offset:2048 lds
    buffer_load_dwordx4 v8, s[12:15], s27 offen offset:3072 lds
    s_add_u32 s27, s27, 128
    s_add_u32 s29, s29, 32768
    s_cmp_ge_u32 s29, 131072
    s_cselect_b32 s29, 0, s29
    s_add_u32 m0, s29, s53
    s_nop 0
    buffer_load_dwordx4 v1, s[8:11], s28 offen lds
    buffer_load_dwordx4 v2, s[8:11], s28 offen offset:1024 lds
    buffer_load_dwordx4 v3, s[8:11], s28 offen offset:2048 lds
    buffer_load_dwordx4 v4, s[8:11], s28 offen offset:3072 lds
    s_add_u32 m0, s29, s54
    s_add_u32 s28, s28, 81920
    buffer_load_dwordx4 v5, s[12:15], s27 offen lds
    buffer_load_dwordx4 v6, s[12:15], s27 offen offset:1024 lds
    buffer_load_dwordx4 v7, s[12:15], s27 offen offset:2048 lds
    buffer_load_dwordx4 v8, s[12:15], s27 offen offset:3072 lds
    s_add_u32 s27, s27, 128
    s_add_u32 s29, s29, 32768
    s_cmp_ge_u32 s29, 131072
    s_cselect_b32 s29, 0, s29
    s_mov_b32 s31, 8
XL_ldloop:
    s_waitcnt vmcnt(8)
    s_barrier
    s_add_u32 m0, s29, s53
    s_nop 0
    buffer_load_dwordx4 v1, s[8:11], s28 offen lds
    buffer_load_dwordx4 v2, s[8:11], s28 offen offset:1024 lds
    buffer_load_dwordx4 v3, s[8:11], s28 offen offset:2048 lds
    buffer_load_dwordx4 v4, s[8:11], s28 offen offset:3072 lds
    s_add_u32 m0, s29, s54
    s_add_u32 s28, s28, 81920
    buffer_load_dwordx4 v5, s[12:15], s27 offen lds
    buffer_load_dwordx4 v6, s[12:15], s27 offen offset:1024 lds
    buffer_load_dwordx4 v7, s[12:15], s27 offen offset:2048 lds
    buffer_load_dwordx4 v8, s[12:15], s27 offen offset:3072 lds
    s_add_u32 s27, s27, 128
    s_add_u32 s29, s29, 32768
    s_cmp_ge_u32 s29, 131072
    s_cselect_b32 s29, 0, s29
    s_sub_u32 s31, s31, 1
    s_cmp_lg_u32 s31, 0
    s_cbranch_scc1 XL_ldloop
    s_waitcnt vmcnt(8)
    s_barrier
    s_waitcnt vmcnt(0)
    s_barrier
    s_endpgm
P1_cons:
    s_waitcnt lgkmcnt(0)
    s_mov_b32 s16, s48
    s_and_b32 s17, s49, 0xffff
    s_mov_b32 s18, 268435456
    s_mov_b32 s19, 0x00020000
    s_cmp_lt_u32 s3, 4
    s_cbranch_scc1 P0_done
    s_cmp_ge_u32 s3, 8
    s_cbranch_scc1 P0_done
    s_sub_u32 s51, s3, 4
    s_lshl_b32 s51, s51, 5
    s_add_u32 s51, s51, s5
    s_lshr_b32 s26, s51, 4
    s_add_u32 s26, s26, 0
    s_and_b32 s51, s51, 15
    s_cmp_ge_u32 s51, 10
    s_cbranch_scc1 P00_tv
    s_lshl_b32 s51, s51, 6
    v_add_u32 v20, s51, v0
    v_lshrrev_b32 v21, 1, v20
    v_and_b32 v20, 1, v20
    s_mov_b32 s53, 6144
    v_mul_lo_u32 v21, v21, s53
    v_lshl_add_u32 v3, v20, 7, v21
    s_and_b32 s27, s4, 1
    s_mul_i32 s27, s27, 1966080
    s_lshl_b32 s52, s26, 8
    s_add_u32 s27, s27, s52
    s_mov_b32 s52, s34
    s_and_b32 s53, s35, 0xffff
    s_mov_b32 s54, 3932160
    s_mov_b32 s55, 0x00020000
    s_branch P00_td
P00_tv:
    s_sub_u32 s51, s51, 10
    s_lshl_b32 s51, s51, 6
    v_add_u32 v20, s51, v0
    v_mul_u32_u24 v21, 171, v20
    v_lshrrev_b32 v21, 10, v21
    v_mul_u32_u24 v22, 6, v21
    v_sub_u32 v20, v20, v22
    s_mov_b32 s53, 3072
    v_mul_lo_u32 v21, v21, s53
    v_lshl_add_u32 v3, v20, 7, v21
    s_lshr_b32 s27, s4, 1
    s_mul_i32 s27, s27, 768
    s_mul_i32 s52, s26, 196608
    s_add_u32 s27, s27, s52
    s_mov_b32 s52, s42
    s_and_b32 s53, s43, 0xffff
    s_mov_b32 s54, 4718592
    s_mov_b32 s55, 0x00020000
P00_td:
    buffer_load_dword v2, v3, s[52:55], s27 offen
P0_done:
    s_cmp_ge_u32 s5, 30
    s_cbranch_scc1 P1_i
    s_cmp_ge_u32 s5, 20
    s_cbranch_scc1 P1_x
    s_mul_i32 s7, s5, 52
    s_lshr_b32 s7, s7, 8
    s_mul_i32 s51, s7, 5
    s_sub_u32 s6, s5, s51
    s_and_b32 s51, s4, 1
    s_mul_i32 s51, s51, 5
    s_add_u32 s6, s6, s51
    s_lshr_b32 s51, s4, 1
    s_lshl_b32 s51, s51, 2
    s_add_u32 s7, s7, s51
    s_cmp_ge_u32 s3, 4
    s_cbranch_scc1 P1_tc1
    s_mov_b32 s20, s38
    s_and_b32 s21, s39, 0xffff
    s_mov_b32 s22, 3072
    s_mov_b32 s23, 0x00020000
    s_mov_b32 s24, s36
    s_and_b32 s25, s37, 0xffff
    s_mov_b32 s26, 3072
    s_mov_b32 s27, 0x00020000
    s_and_b32 s50, s3, 3
    v_and_b32 v60, 15, v0
    v_lshrrev_b32 v61, 4, v0
    s_cmp_ge_u32 s3, 3
    s_cbranch_scc1 TC0_nozs
    s_lshl_b32 s51, s3, 10
    v_lshlrev_b32 v62, 4, v0
    v_add_u32 v62, s51, v62
    buffer_load_dwordx4 v[64:67], v62, s[20:23], 0 offen
    buffer_load_dwordx4 v[68:71], v62, s[24:27], 0 offen
    s_waitcnt vmcnt(0)
    v_lshlrev_b32 v16, 16, v64
    v_and_b32 v17, 0xffff0000, v64
    v_lshlrev_b32 v24, 16, v68
    v_and_b32 v25, 0xffff0000, v68
    v_lshlrev_b32 v18, 16, v65
    v_and_b32 v19, 0xffff0000, v65
    v_lshlrev_b32 v26, 16, v69
    v_and_b32 v27, 0xffff0000, v69
    v_lshlrev_b32 v20, 16, v66
    v_and_b32 v21, 0xffff0000, v66
    v_lshlrev_b32 v28, 16, v70
    v_and_b32 v29, 0xffff0000, v70
    v_lshlrev_b32 v22, 16, v67
    v_and_b32 v23, 0xffff0000, v67
    v_lshlrev_b32 v30, 16, v71
    v_and_b32 v31, 0xffff0000, v71
    v_xor_b32 v16, 0x80000000, v16
    v_xor_b32 v17, 0x80000000, v17
    v_xor_b32 v18, 0x80000000, v18
    v_xor_b32 v19, 0x80000000, v19
    v_xor_b32 v20, 0x80000000, v20
    v_xor_b32 v21, 0x80000000, v21
    v_xor_b32 v22, 0x80000000, v22
    v_xor_b32 v23, 0x80000000, v23
    s_lshl_b32 s51, s3, 12
    v_lshlrev_b32 v62, 6, v0
    v_add_u32 v62, s51, v62
    v_add_u32 v62, 143360, v62
    ds_write_b128 v62, v[16:19]
    ds_write_b128 v62, v[20:23] offset:16
    ds_write_b128 v62, v[24:27] offset:32
    ds_write_b128 v62, v[28:31] offset:48
    s_waitcnt lgkmcnt(0)
TC0_nozs:
    s_add_u32 s26, s5, 8
    s_mov_b32 s51, s3
    s_cmp_ge_u32 s51, 10
    s_cbranch_scc1 TC0_tv
    s_lshl_b32 s51, s51, 6
    v_add_u32 v62, s51, v0
    v_lshrrev_b32 v63, 1, v62
    v_and_b32 v62, 1, v62
    s_mov_b32 s53, 6144
    v_mul_lo_u32 v63, v63, s53
    v_lshl_add_u32 v3, v62, 7, v63
    s_and_b32 s27, s4, 1
    s_mul_i32 s27, s27, 1966080
    s_lshl_b32 s52, s26, 8
    s_add_u32 s27, s27, s52
    s_mov_b32 s52, s34
    s_and_b32 s53, s35, 0xffff
    s_mov_b32 s54, 3932160
    s_mov_b32 s55, 0x00020000
    s_branch TC0_td
TC0_tv:
    s_sub_u32 s51, s51, 10
    s_lshl_b32 s51, s51, 6
    v_add_u32 v62, s51, v0
    v_mul_u32_u24 v63, 171, v62
    v_lshrrev_b32 v63, 10, v63
    v_mul_u32_u24 v64, 6, v63
    v_sub_u32 v62, v62, v64
    s_mov_b32 s53, 3072
    v_mul_lo_u32 v63, v63, s53
    v_lshl_add_u32 v3, v62, 7, v63
    s_lshr_b32 s27, s4, 1
    s_mul_i32 s27, s27, 768
    s_mul_i32 s52, s26, 196608
    s_add_u32 s27, s27, s52
    s_mov_b32 s52, s42
    s_and_b32 s53, s43, 0xffff
    s_mov_b32 s54, 4718592
    s_mov_b32 s55, 0x00020000
TC0_td:
    s_cmp_ge_u32 s3, 4
    s_cselect_b32 s26, 100, s26
    s_mov_b32 s28, 0
    s_mov_b32 s25, 10
    s_cmp_gt_u32 s26, s25
    s_cbranch_scc1 TC0p0_nt
    s_cmp_ge_u32 s26, 24
    s_cbranch_scc1 TC0p0_nt
    buffer_load_dword v2, v3, s[52:55], s27 offen
    s_add_u32 s26, s26, 100
    s_add_u32 s27, s27, s28
TC0p0_nt:
    s_and_b32 s56, s3, 1
    s_lshr_b32 s57, s3, 1
    s_and_b32 s57, s57, 1
    s_lshl_b32 s51, s57, 3
    v_lshlrev_b32 v62, 1, v61
    v_add_u32 v62, s51, v62
    v_xor_b32 v62, v62, v60
    v_lshlrev_b32 v62, 4, v62
    v_lshl_add_u32 v62, v60, 8, v62
    s_lshl_b32 s51, s56, 13
    s_add_u32 s51, s51, 0
    v_add_u32 v5, s51, v62
    v_xor_b32 v6, 16, v5
    v_lshlrev_b32 v4, 2, v0
    s_lshl_b32 s51, s57, 8
    s_add_u32 s51, s51, 143360
    v_add_u32 v4, s51, v4
    v_lshlrev_b32 v9, 6, v61
    v_add_u32 v9, s51, v9
    v_lshrrev_b32 v62, 2, v60
    v_lshl_add_u32 v62, v61, 3, v62
    v_mul_u32_u24 v62, 192, v62
    v_and_b32 v63, 3, v60
    v_lshl_add_u32 v62, v63, 3, v62
    s_mul_i32 s51, s57, 6144
    s_add_u32 s51, s51, 16384
    v_add_u32 v62, s51, v62
    v_and_b32 v63, 1, v61
    v_lshl_add_u32 v10, v63, 5, v62
    v_xor_b32 v63, 1, v63
    v_lshl_add_u32 v11, v63, 5, v62
    v_mov_b32 v100, 0
    v_mov_b32 v101, 0
    v_mov_b32 v102, 0
    v_mov_b32 v103, 0
    v_mov_b32 v104, 0
    v_mov_b32 v105, 0
    v_mov_b32 v106, 0
    v_mov_b32 v107, 0
    v_mov_b32 v108, 0
    v_mov_b32 v109, 0
    v_mov_b32 v110, 0
    v_mov_b32 v111, 0
    v_mov_b32 v112, 0
    v_mov_b32 v113, 0
    v_mov_b32 v114, 0
    v_mov_b32 v115, 0
    v_mov_b32 v116, 0
    v_mov_b32 v117, 0
    v_mov_b32 v118, 0
    v_mov_b32 v119, 0
    v_mov_b32 v120, 0
    v_mov_b32 v121, 0
    v_mov_b32 v122, 0
    v_mov_b32 v123, 0
    v_mov_b32 v124, 0
    v_mov_b32 v125, 0
    v_mov_b32 v126, 0
    v_mov_b32 v127, 0
    v_mov_b32 v128, 0
    v_mov_b32 v129, 0
    v_mov_b32 v130, 0
    v_mov_b32 v131, 0
    v_mov_b32 v132, 0
    v_mov_b32 v133, 0
    v_mov_b32 v134, 0
    v_mov_b32 v135, 0
    v_mov_b32 v136, 0
    v_mov_b32 v137, 0
    v_mov_b32 v138, 0
    v_mov_b32 v139, 0
    v_mov_b32 v140, 0
    v_mov_b32 v141, 0
    v_mov_b32 v142, 0
    v_mov_b32 v143, 0
    v_mov_b32 v144, 0
    v_mov_b32 v145, 0
    v_mov_b32 v146, 0
    v_mov_b32 v147, 0
    v_mov_b32 v76, 0
    v_mov_b32 v77, 0
    v_mov_b32 v78, 0
    v_mov_b32 v79, 0
    v_mov_b32 v80, 0
    v_mov_b32 v81, 0
    v_mov_b32 v82, 0
    v_mov_b32 v83, 0
    v_mov_b32 v84, 0
    v_mov_b32 v85, 0
    v_mov_b32 v86, 0
    v_mov_b32 v87, 0
    v_mov_b32 v88, 0
    v_mov_b32 v89, 0
    v_mov_b32 v90, 0
    v_mov_b32 v91, 0
    v_mov_b32 v92, 0
    v_mov_b32 v93, 0
    v_mov_b32 v94, 0
    v_mov_b32 v95, 0
    v_mov_b32 v96, 0
    v_mov_b32 v97, 0
    v_mov_b32 v98, 0
    v_mov_b32 v99, 0
    v_mov_b32 v34, 0
    v_mov_b32 v35, 0
    v_mov_b32 v36, 0
    v_mov_b32 v37, 0
    v_mov_b32 v38, 0
    v_mov_b32 v39, 0
    v_mov_b32 v40, 0
    v_mov_b32 v41, 0
    v_mov_b32 v43, 0
    s_mov_b32 s30, 0
    s_mov_b32 s31, 6
    v_mov_b32 v164, 0
    v_mov_b32 v165, 0
    v_mov_b32 v166, 0
    v_mov_b32 v167, 0
TC0_loop:
    s_barrier
    v_add_u32 v12, s30, v5
    v_add_u32 v13, s30, v6
    v_add_u32 v16, s30, v10
    v_add_u32 v17, s30, v11
    ds_read_b128 v[18:21], v12
    ds_read_b128 v[22:25], v13
    ds_read_b128 v[26:29], v12 offset:4096
    ds_read_b128 v[30:33], v13 offset:4096
    ds_read_b32 v42, v4
    ds_read_b64_tr_b16 v[52:53], v16 offset:0
    v_mfma_f32_16x16x32_bf16 v[124:127], v[164:167], v[76:79], v[124:127]
    ds_read_b64_tr_b16 v[54:55], v16 offset:768
    ds_read_b64_tr_b16 v[56:57], v17 offset:0
    v_mfma_f32_16x16x32_bf16 v[128:131], v[164:167], v[80:83], v[128:131]
    ds_read_b64_tr_b16 v[58:59], v17 offset:768
    ds_read_b64_tr_b16 v[60:61], v16 offset:64
    v_mfma_f32_16x16x32_bf16 v[132:135], v[164:167], v[84:87], v[132:135]
    ds_read_b64_tr_b16 v[62:63], v16 offset:832
    ds_read_b64_tr_b16 v[64:65], v17 offset:64
    v_mfma_f32_16x16x32_bf16 v[136:139], v[164:167], v[88:91], v[136:139]
    ds_read_b64_tr_b16 v[66:67], v17 offset:832
    ds_read_b64_tr_b16 v[68:69], v16 offset:128
    v_mfma_f32_16x16x32_bf16 v[140:143], v[164:167], v[92:95], v[140:143]
    ds_read_b64_tr_b16 v[70:71], v16 offset:896
    ds_read_b64_tr_b16 v[72:73], v17 offset:128
    v_mfma_f32_16x16x32_bf16 v[144:147], v[164:167], v[96:99], v[144:147]
    ds_read_b64_tr_b16 v[74:75], v17 offset:896
    v_add_u32 v4, 1024, v4
    v_add_u32 v9, 1024, v9
    s_add_u32 s30, s30, 57344
    s_cmp_ge_u32 s30, 143360
    s_cselect_b32 s51, 143360, 0
    s_sub_u32 s30, s30, s51
    s_waitcnt lgkmcnt(0)
    s_barrier
    s_add_u32 s25, s25, 2
    s_cmp_gt_u32 s26, s25
    s_cbranch_scc1 TC0la_nt
    s_cmp_ge_u32 s26, 24
    s_cbranch_scc1 TC0la_nt
    buffer_load_dword v2, v3, s[52:55], s27 offen
    s_add_u32 s26, s26, 100
    s_add_u32 s27, s27, s28
TC0la_nt:
    v_cvt_f32_i32 v18, v18
    v_cvt_f32_i32 v19, v19
    v_cvt_f32_i32 v20, v20
    v_cvt_f32_i32 v21, v21
    v_cvt_f32_i32 v22, v22
    v_cvt_f32_i32 v23, v23
    v_cvt_f32_i32 v24, v24
    v_cvt_f32_i32 v25, v25
    v_add_f32_dpp v18, v42, v18 row_newbcast:0 row_mask:0xf bank_mask:0xf
    v_add_f32_dpp v19, v42, v19 row_newbcast:1 row_mask:0xf bank_mask:0xf
    v_add_f32_dpp v20, v42, v20 row_newbcast:2 row_mask:0xf bank_mask:0xf
    v_add_f32_dpp v21, v42, v21 row_newbcast:3 row_mask:0xf bank_mask:0xf
    v_add_f32_dpp v22, v42, v22 row_newbcast:4 row_mask:0xf bank_mask:0xf
    v_add_f32_dpp v23, v42, v23 row_newbcast:5 row_mask:0xf bank_mask:0xf
    v_add_f32_dpp v24, v42, v24 row_newbcast:6 row_mask:0xf bank_mask:0xf
    v_add_f32_dpp v25, v42, v25 row_newbcast:7 row_mask:0xf bank_mask:0xf
    v_cvt_pk_bf16_f32 v44, v18, v19
    v_cvt_pk_bf16_f32 v45, v20, v21
    v_cvt_pk_bf16_f32 v46, v22, v23
    v_cvt_pk_bf16_f32 v47, v24, v25
    v_lshlrev_b32 v18, 16, v44
    v_and_b32 v19, 0xffff0000, v44
    v_lshlrev_b32 v20, 16, v45
    v_and_b32 v21, 0xffff0000, v45
    v_lshlrev_b32 v22, 16, v46
    v_and_b32 v23, 0xffff0000, v46
    v_lshlrev_b32 v24, 16, v47
    v_and_b32 v25, 0xffff0000, v47
    v_mul_f32_dpp v18, v42, v18 row_newbcast:8 row_mask:0xf bank_mask:0xf
    v_mul_f32_dpp v19, v42, v19 row_newbcast:9 row_mask:0xf bank_mask:0xf
    v_mul_f32_dpp v20, v42, v20 row_newbcast:10 row_mask:0xf bank_mask:0xf
    v_mul_f32_dpp v21, v42, v21 row_newbcast:11 row_mask:0xf bank_mask:0xf
    v_mul_f32_dpp v22, v42, v22 row_newbcast:12 row_mask:0xf bank_mask:0xf
    v_mul_f32_dpp v23, v42, v23 row_newbcast:13 row_mask:0xf bank_mask:0xf
    v_mul_f32_dpp v24, v42, v24 row_newbcast:14 row_mask:0xf bank_mask:0xf
    v_mul_f32_dpp v25, v42, v25 row_newbcast:15 row_mask:0xf bank_mask:0xf
    v_cvt_pk_bf16_f32 v48, v18, v19
    v_cvt_pk_bf16_f32 v49, v20, v21
    v_cvt_pk_bf16_f32 v50, v22, v23
    v_cvt_pk_bf16_f32 v51, v24, v25
    v_cvt_f32_i32 v26, v26
    v_cvt_f32_i32 v27, v27
    v_mfma_f32_16x16x32_bf16 v[100:103], v[48:51], v[52:55], v[100:103]
    v_cvt_f32_i32 v28, v28
    v_cvt_f32_i32 v29, v29
    v_cvt_f32_i32 v30, v30
    v_cvt_f32_i32 v31, v31
    v_cvt_f32_i32 v32, v32
    v_cvt_f32_i32 v33, v33
    v_add_f32_dpp v26, v42, v26 row_newbcast:0 row_mask:0xf bank_mask:0xf
    v_mfma_f32_16x16x32_bf16 v[104:107], v[48:51], v[56:59], v[104:107]
    v_add_f32_dpp v27, v42, v27 row_newbcast:1 row_mask:0xf bank_mask:0xf
    v_add_f32_dpp v28, v42, v28 row_newbcast:2 row_mask:0xf bank_mask:0xf
    v_add_f32_dpp v29, v42, v29 row_newbcast:3 row_mask:0xf bank_mask:0xf
    v_add_f32_dpp v30, v42, v30 row_newbcast:4 row_mask:0xf bank_mask:0xf
    v_add_f32_dpp v31, v42, v31 row_newbcast:5 row_mask:0xf bank_mask:0xf
    v_add_f32_dpp v32, v42, v32 row_newbcast:6 row_mask:0xf bank_mask:0xf
    v_add_f32_dpp v33, v42, v33 row_newbcast:7 row_mask:0xf bank_mask:0xf
    v_mfma_f32_16x16x32_bf16 v[108:111], v[48:51], v[60:63], v[108:111]
    v_cvt_pk_bf16_f32 v44, v26, v27
    v_cvt_pk_bf16_f32 v45, v28, v29
    v_cvt_pk_bf16_f32 v46, v30, v31
    v_cvt_pk_bf16_f32 v47, v32, v33
    v_lshlrev_b32 v26, 16, v44
    v_and_b32 v27, 0xffff0000, v44
    v_lshlrev_b32 v28, 16, v45
    v_mfma_f32_16x16x32_bf16 v[112:115], v[48:51], v[64:67], v[112:115]
    v_and_b32 v29, 0xffff0000, v45
    v_lshlrev_b32 v30, 16, v46
    v_and_b32 v31, 0xffff0000, v46
    v_lshlrev_b32 v32, 16, v47
    v_and_b32 v33, 0xffff0000, v47
    v_mul_f32_dpp v26, v42, v26 row_newbcast:8 row_mask:0xf bank_mask:0xf
    v_mul_f32_dpp v27, v42, v27 row_newbcast:9 row_mask:0xf bank_mask:0xf
    v_mfma_f32_16x16x32_bf16 v[116:119], v[48:51], v[68:71], v[116:119]
    v_mul_f32_dpp v28, v42, v28 row_newbcast:10 row_mask:0xf bank_mask:0xf
    v_mul_f32_dpp v29, v42, v29 row_newbcast:11 row_mask:0xf bank_mask:0xf
    v_mul_f32_dpp v30, v42, v30 row_newbcast:12 row_mask:0xf bank_mask:0xf
    v_mul_f32_dpp v31, v42, v31 row_newbcast:13 row_mask:0xf bank_mask:0xf
    v_mul_f32_dpp v32, v42, v32 row_newbcast:14 row_mask:0xf bank_mask:0xf
    v_mul_f32_dpp v33, v42, v33 row_newbcast:15 row_mask:0xf bank_mask:0xf
    v_cvt_pk_bf16_f32 v164, v26, v27
    v_mfma_f32_16x16x32_bf16 v[120:123], v[48:51], v[72:75], v[120:123]
    v_cvt_pk_bf16_f32 v165, v28, v29
    v_cvt_pk_bf16_f32 v166, v30, v31
    v_cvt_pk_bf16_f32 v167, v32, v33
    s_barrier
    v_add_u32 v12, s30, v5
    v_add_u32 v13, s30, v6
    v_add_u32 v16, s30, v10
    v_add_u32 v17, s30, v11
    ds_read_b128 v[18:21], v12
    ds_read_b128 v[22:25], v13
    ds_read_b128 v[34:37], v12 offset:4096
    ds_read_b128 v[38:41], v13 offset:4096
    ds_read_b32 v43, v4
    ds_read_b64_tr_b16 v[76:77], v16 offset:0
    v_mfma_f32_16x16x32_bf16 v[124:127], v[164:167], v[52:55], v[124:127]
    ds_read_b64_tr_b16 v[78:79], v16 offset:768
    ds_read_b64_tr_b16 v[80:81], v17 offset:0
    v_mfma_f32_16x16x32_bf16 v[128:131], v[164:167], v[56:59], v[128:131]
    ds_read_b64_tr_b16 v[82:83], v17 offset:768
    ds_read_b64_tr_b16 v[84:85], v16 offset:64
    v_mfma_f32_16x16x32_bf16 v[132:135], v[164:167], v[60:63], v[132:135]
    ds_read_b64_tr_b16 v[86:87], v16 offset:832
    ds_read_b64_tr_b16 v[88:89], v17 offset:64
    v_mfma_f32_16x16x32_bf16 v[136:139], v[164:167], v[64:67], v[136:139]
    ds_read_b64_tr_b16 v[90:91], v17 offset:832
    ds_read_b64_tr_b16 v[92:93], v16 offset:128
    v_mfma_f32_16x16x32_bf16 v[140:143], v[164:167], v[68:71], v[140:143]
    ds_read_b64_tr_b16 v[94:95], v16 offset:896
    ds_read_b64_tr_b16 v[96:97], v17 offset:128
    v_mfma_f32_16x16x32_bf16 v[144:147], v[164:167], v[72:75], v[144:147]
    ds_read_b64_tr_b16 v[98:99], v17 offset:896
    v_add_u32 v4, 1024, v4
    v_add_u32 v9, 1024, v9
    s_add_u32 s30, s30, 57344
    s_cmp_ge_u32 s30, 143360
    s_cselect_b32 s51, 143360, 0
    s_sub_u32 s30, s30, s51
    s_waitcnt lgkmcnt(0)
    s_barrier
    s_add_u32 s25, s25, 2
    s_cmp_gt_u32 s26, s25
    s_cbranch_scc1 TC0lb_nt
    s_cmp_ge_u32 s26, 24
    s_cbranch_scc1 TC0lb_nt
    buffer_load_dword v2, v3, s[52:55], s27 offen
    s_add_u32 s26, s26, 100
    s_add_u32 s27, s27, s28
TC0lb_nt:
    v_cvt_f32_i32 v18, v18
    v_cvt_f32_i32 v19, v19
    v_cvt_f32_i32 v20, v20
    v_cvt_f32_i32 v21, v21
    v_cvt_f32_i32 v22, v22
    v_cvt_f32_i32 v23, v23
    v_cvt_f32_i32 v24, v24
    v_cvt_f32_i32 v25, v25
    v_add_f32_dpp v18, v43, v18 row_newbcast:0 row_mask:0xf bank_mask:0xf
    v_add_f32_dpp v19, v43, v19 row_newbcast:1 row_mask:0xf bank_mask:0xf
    v_add_f32_dpp v20, v43, v20 row_newbcast:2 row_mask:0xf bank_mask:0xf
    v_add_f32_dpp v21, v43, v21 row_newbcast:3 row_mask:0xf bank_mask:0xf
    v_add_f32_dpp v22, v43, v22 row_newbcast:4 row_mask:0xf bank_mask:0xf
    v_add_f32_dpp v23, v43, v23 row_newbcast:5 row_mask:0xf bank_mask:0xf
    v_add_f32_dpp v24, v43, v24 row_newbcast:6 row_mask:0xf bank_mask:0xf
    v_add_f32_dpp v25, v43, v25 row_newbcast:7 row_mask:0xf bank_mask:0xf
    v_cvt_pk_bf16_f32 v44, v18, v19
    v_cvt_pk_bf16_f32 v45, v20, v21
    v_cvt_pk_bf16_f32 v46, v22, v23
    v_cvt_pk_bf16_f32 v47, v24, v25
    v_lshlrev_b32 v18, 16, v44
    v_and_b32 v19, 0xffff0000, v44
    v_lshlrev_b32 v20, 16, v45
    v_and_b32 v21, 0xffff0000, v45
    v_lshlrev_b32 v22, 16, v46
    v_and_b32 v23, 0xffff0000, v46
    v_lshlrev_b32 v24, 16, v47
    v_and_b32 v25, 0xffff0000, v47
    v_mul_f32_dpp v18, v43, v18 row_newbcast:8 row_mask:0xf bank_mask:0xf
    v_mul_f32_dpp v19, v43, v19 row_newbcast:9 row_mask:0xf bank_mask:0xf
    v_mul_f32_dpp v20, v43, v20 row_newbcast:10 row_mask:0xf bank_mask:0xf
    v_mul_f32_dpp v21, v43, v21 row_newbcast:11 row_mask:0xf bank_mask:0xf
    v_mul_f32_dpp v22, v43, v22 row_newbcast:12 row_mask:0xf bank_mask:0xf
    v_mul_f32_dpp v23, v43, v23 row_newbcast:13 row_mask:0xf bank_mask:0xf
    v_mul_f32_dpp v24, v43, v24 row_newbcast:14 row_mask:0xf bank_mask:0xf
    v_mul_f32_dpp v25, v43, v25 row_newbcast:15 row_mask:0xf bank_mask:0xf
    v_cvt_pk_bf16_f32 v48, v18, v19
    v_cvt_pk_bf16_f32 v49, v20, v21
    v_cvt_pk_bf16_f32 v50, v22, v23
    v_cvt_pk_bf16_f32 v51, v24, v25
    v_cvt_f32_i32 v34, v34
    v_cvt_f32_i32 v35, v35
    v_mfma_f32_16x16x32_bf16 v[100:103], v[48:51], v[76:79], v[100:103]
    v_cvt_f32_i32 v36, v36
    v_cvt_f32_i32 v37, v37
    v_cvt_f32_i32 v38, v38
    v_cvt_f32_i32 v39, v39
    v_cvt_f32_i32 v40, v40
    v_cvt_f32_i32 v41, v41
    v_add_f32_dpp v34, v43, v34 row_newbcast:0 row_mask:0xf bank_mask:0xf
    v_mfma_f32_16x16x32_bf16 v[104:107], v[48:51], v[80:83], v[104:107]
    v_add_f32_dpp v35, v43, v35 row_newbcast:1 row_mask:0xf bank_mask:0xf
    v_add_f32_dpp v36, v43, v36 row_newbcast:2 row_mask:0xf bank_mask:0xf
    v_add_f32_dpp v37, v43, v37 row_newbcast:3 row_mask:0xf bank_mask:0xf
    v_add_f32_dpp v38, v43, v38 row_newbcast:4 row_mask:0xf bank_mask:0xf
    v_add_f32_dpp v39, v43, v39 row_newbcast:5 row_mask:0xf bank_mask:0xf
    v_add_f32_dpp v40, v43, v40 row_newbcast:6 row_mask:0xf bank_mask:0xf
    v_add_f32_dpp v41, v43, v41 row_newbcast:7 row_mask:0xf bank_mask:0xf
    v_mfma_f32_16x16x32_bf16 v[108:111], v[48:51], v[84:87], v[108:111]
    v_cvt_pk_bf16_f32 v44, v34, v35
    v_cvt_pk_bf16_f32 v45, v36, v37
    v_cvt_pk_bf16_f32 v46, v38, v39
    v_cvt_pk_bf16_f32 v47, v40, v41
    v_lshlrev_b32 v34, 16, v44
    v_and_b32 v35, 0xffff0000, v44
    v_lshlrev_b32 v36, 16, v45
    v_mfma_f32_16x16x32_bf16 v[112:115], v[48:51], v[88:91], v[112:115]
    v_and_b32 v37, 0xffff0000, v45
    v_lshlrev_b32 v38, 16, v46
    v_and_b32 v39, 0xffff0000, v46
    v_lshlrev_b32 v40, 16, v47
    v_and_b32 v41, 0xffff0000, v47
    v_mul_f32_dpp v34, v43, v34 row_newbcast:8 row_mask:0xf bank_mask:0xf
    v_mul_f32_dpp v35, v43, v35 row_newbcast:9 row_mask:0xf bank_mask:0xf
    v_mfma_f32_16x16x32_bf16 v[116:119], v[48:51], v[92:95], v[116:119]
    v_mul_f32_dpp v36, v43, v36 row_newbcast:10 row_mask:0xf bank_mask:0xf
    v_mul_f32_dpp v37, v43, v37 row_newbcast:11 row_mask:0xf bank_mask:0xf
    v_mul_f32_dpp v38, v43, v38 row_newbcast:12 row_mask:0xf bank_mask:0xf
    v_mul_f32_dpp v39, v43, v39 row_newbcast:13 row_mask:0xf bank_mask:0xf
    v_mul_f32_dpp v40, v43, v40 row_newbcast:14 row_mask:0xf bank_mask:0xf
    v_mul_f32_dpp v41, v43, v41 row_newbcast:15 row_mask:0xf bank_mask:0xf
    v_cvt_pk_bf16_f32 v164, v34, v35
    v_mfma_f32_16x16x32_bf16 v[120:123], v[48:51], v[96:99], v[120:123]
    v_cvt_pk_bf16_f32 v165, v36, v37
    v_cvt_pk_bf16_f32 v166, v38, v39
    v_cvt_pk_bf16_f32 v167, v40, v41
    s_sub_u32 s31, s31, 1
    s_cmp_lg_u32 s31, 0
    s_cbranch_scc1 TC0_loop
    s_barrier
    s_nop 1
    v_mfma_f32_16x16x32_bf16 v[124:127], v[164:167], v[76:79], v[124:127]
    v_mfma_f32_16x16x32_bf16 v[128:131], v[164:167], v[80:83], v[128:131]
    v_mfma_f32_16x16x32_bf16 v[132:135], v[164:167], v[84:87], v[132:135]
    v_mfma_f32_16x16x32_bf16 v[136:139], v[164:167], v[88:91], v[136:139]
    v_mfma_f32_16x16x32_bf16 v[140:143], v[164:167], v[92:95], v[140:143]
    v_mfma_f32_16x16x32_bf16 v[144:147], v[164:167], v[96:99], v[144:147]
    s_mul_i32 s51, s56, 49152
    s_mul_i32 s52, s57, 12288
    s_add_u32 s51, s51, s52
    s_add_u32 s51, s51, 0
    v_lshlrev_b32 v15, 4, v0
    v_add_u32 v14, s51, v15
    s_mul_i32 s51, s56, 49152
    v_add_u32 v13, s51, v15
    s_nop 7
    s_cmp_eq_u32 s57, 1
    s_cbranch_scc1 TC0_ep1
    ds_write_b128 v14, v[108:111] offset:2048
    ds_write_b128 v14, v[112:115] offset:3072
    ds_write_b128 v14, v[116:119] offset:4096
    ds_write_b128 v14, v[120:123] offset:5120
    ds_write_b128 v14, v[132:135] offset:8192
    ds_write_b128 v14, v[136:139] offset:9216
    ds_write_b128 v14, v[140:143] offset:10240
    ds_write_b128 v14, v[144:147] offset:11264
    s_lshl_b32 s51, s6, 1
    s_add_u32 s51, s51, s56
    s_mul_i32 s54, s7, 120
    s_add_u32 s54, s54, s51
    s_add_u32 s54, s54, 0
    s_lshl_b32 s54, s54, 10
    s_add_u32 s54, s54, 2621440
    s_add_u32 s55, s54, 20480
    s_waitcnt lgkmcnt(0)
    s_barrier
    ds_read_b128 v[20:23], v13 offset:12288
    ds_read_b128 v[24:27], v13 offset:24576
    ds_read_b128 v[28:31], v13 offset:36864
    ds_read_b128 v[32:35], v13 offset:18432
    ds_read_b128 v[36:39], v13 offset:30720
    ds_read_b128 v[40:43], v13 offset:43008
    ds_read_b128 v[44:47], v13 offset:13312
    ds_read_b128 v[48:51], v13 offset:25600
    ds_read_b128 v[52:55], v13 offset:37888
    ds_read_b128 v[56:59], v13 offset:19456
    ds_read_b128 v[60:63], v13 offset:31744
    ds_read_b128 v[64:67], v13 offset:44032
    s_waitcnt lgkmcnt(9)
    v_add_f32 v100, v100, v20
    v_add_f32 v101, v101, v21
    v_add_f32 v102, v102, v22
    v_add_f32 v103, v103, v23
    v_add_f32 v100, v100, v24
    v_add_f32 v101, v101, v25
    v_add_f32 v102, v102, v26
    v_add_f32 v103, v103, v27
    v_add_f32 v100, v100, v28
    v_add_f32 v101, v101, v29
    v_add_f32 v102, v102, v30
    v_add_f32 v103, v103, v31
    v_cvt_pk_bf16_f32 v72, v100, v101
    v_cvt_pk_bf16_f32 v73, v102, v103
    s_waitcnt lgkmcnt(6)
    v_add_f32 v124, v124, v32
    v_add_f32 v125, v125, v33
    v_add_f32 v126, v126, v34
    v_add_f32 v127, v127, v35
    v_add_f32 v124, v124, v36
    v_add_f32 v125, v125, v37
    v_add_f32 v126, v126, v38
    v_add_f32 v127, v127, v39
    v_add_f32 v124, v124, v40
    v_add_f32 v125, v125, v41
    v_add_f32 v126, v126, v42
    v_add_f32 v127, v127, v43
    v_cvt_pk_bf16_f32 v74, v124, v125
    v_cvt_pk_bf16_f32 v75, v126, v127
    buffer_store_dwordx4 v[72:75], v15, s[16:19], s54 offen sc1
    s_waitcnt lgkmcnt(3)
    v_add_f32 v104, v104, v44
    v_add_f32 v105, v105, v45
    v_add_f32 v106, v106, v46
    v_add_f32 v107, v107, v47
    v_add_f32 v104, v104, v48
    v_add_f32 v105, v105, v49
    v_add_f32 v106, v106, v50
    v_add_f32 v107, v107, v51
    v_add_f32 v104, v104, v52
    v_add_f32 v105, v105, v53
    v_add_f32 v106, v106, v54
    v_add_f32 v107, v107, v55
    v_cvt_pk_bf16_f32 v76, v104, v105
    v_cvt_pk_bf16_f32 v77, v106, v107
    s_waitcnt lgkmcnt(0)
    v_add_f32 v128, v128, v56
    v_add_f32 v129, v129, v57
    v_add_f32 v130, v130, v58
    v_add_f32 v131, v131, v59
    v_add_f32 v128, v128, v60
    v_add_f32 v129, v129, v61
    v_add_f32 v130, v130, v62
    v_add_f32 v131, v131, v63
    v_add_f32 v128, v128, v64
    v_add_f32 v129, v129, v65
    v_add_f32 v130, v130, v66
    v_add_f32 v131, v131, v67
    v_cvt_pk_bf16_f32 v78, v128, v129
    v_cvt_pk_bf16_f32 v79, v130, v131
    buffer_store_dwordx4 v[76:79], v15, s[16:19], s55 offen sc1
    s_endpgm
TC0_ep1:
    ds_write_b128 v14, v[100:103] offset:0
    ds_write_b128 v14, v[104:107] offset:1024
    ds_write_b128 v14, v[116:119] offset:4096
    ds_write_b128 v14, v[120:123] offset:5120
    ds_write_b128 v14, v[124:127] offset:6144
    ds_write_b128 v14, v[128:131] offset:7168
    ds_write_b128 v14, v[140:143] offset:10240
    ds_write_b128 v14, v[144:147] offset:11264
    s_lshl_b32 s51, s6, 1
    s_add_u32 s51, s51, s56
    s_mul_i32 s54, s7, 120
    s_add_u32 s54, s54, s51
    s_add_u32 s54, s54, 40
    s_lshl_b32 s54, s54, 10
    s_add_u32 s54, s54, 2621440
    s_add_u32 s55, s54, 20480
    s_waitcnt lgkmcnt(0)
    s_barrier
    ds_read_b128 v[20:23], v13 offset:2048
    ds_read_b128 v[24:27], v13 offset:26624
    ds_read_b128 v[28:31], v13 offset:38912
    ds_read_b128 v[32:35], v13 offset:8192
    ds_read_b128 v[36:39], v13 offset:32768
    ds_read_b128 v[40:43], v13 offset:45056
    ds_read_b128 v[44:47], v13 offset:3072
    ds_read_b128 v[48:51], v13 offset:27648
    ds_read_b128 v[52:55], v13 offset:39936
    ds_read_b128 v[56:59], v13 offset:9216
    ds_read_b128 v[60:63], v13 offset:33792
    ds_read_b128 v[64:67], v13 offset:46080
    s_waitcnt lgkmcnt(9)
    v_add_f32 v108, v108, v20
    v_add_f32 v109, v109, v21
    v_add_f32 v110, v110, v22
    v_add_f32 v111, v111, v23
    v_add_f32 v108, v108, v24
    v_add_f32 v109, v109, v25
    v_add_f32 v110, v110, v26
    v_add_f32 v111, v111, v27
    v_add_f32 v108, v108, v28
    v_add_f32 v109, v109, v29
    v_add_f32 v110, v110, v30
    v_add_f32 v111, v111, v31
    v_cvt_pk_bf16_f32 v72, v108, v109
    v_cvt_pk_bf16_f32 v73, v110, v111
    s_waitcnt lgkmcnt(6)
    v_add_f32 v132, v132, v32
    v_add_f32 v133, v133, v33
    v_add_f32 v134, v134, v34
    v_add_f32 v135, v135, v35
    v_add_f32 v132, v132, v36
    v_add_f32 v133, v133, v37
    v_add_f32 v134, v134, v38
    v_add_f32 v135, v135, v39
    v_add_f32 v132, v132, v40
    v_add_f32 v133, v133, v41
    v_add_f32 v134, v134, v42
    v_add_f32 v135, v135, v43
    v_cvt_pk_bf16_f32 v74, v132, v133
    v_cvt_pk_bf16_f32 v75, v134, v135
    buffer_store_dwordx4 v[72:75], v15, s[16:19], s54 offen sc1
    s_waitcnt lgkmcnt(3)
    v_add_f32 v112, v112, v44
    v_add_f32 v113, v113, v45
    v_add_f32 v114, v114, v46
    v_add_f32 v115, v115, v47
    v_add_f32 v112, v112, v48
    v_add_f32 v113, v113, v49
    v_add_f32 v114, v114, v50
    v_add_f32 v115, v115, v51
    v_add_f32 v112, v112, v52
    v_add_f32 v113, v113, v53
    v_add_f32 v114, v114, v54
    v_add_f32 v115, v115, v55
    v_cvt_pk_bf16_f32 v76, v112, v113
    v_cvt_pk_bf16_f32 v77, v114, v115
    s_waitcnt lgkmcnt(0)
    v_add_f32 v136, v136, v56
    v_add_f32 v137, v137, v57
    v_add_f32 v138, v138, v58
    v_add_f32 v139, v139, v59
    v_add_f32 v136, v136, v60
    v_add_f32 v137, v137, v61
    v_add_f32 v138, v138, v62
    v_add_f32 v139, v139, v63
    v_add_f32 v136, v136, v64
    v_add_f32 v137, v137, v65
    v_add_f32 v138, v138, v66
    v_add_f32 v139, v139, v67
    v_cvt_pk_bf16_f32 v78, v136, v137
    v_cvt_pk_bf16_f32 v79, v138, v139
    buffer_store_dwordx4 v[76:79], v15, s[16:19], s55 offen sc1
    s_endpgm
P1_tc1:
    s_and_b32 s50, s3, 3
    v_and_b32 v60, 15, v0
    v_lshrrev_b32 v61, 4, v0
    s_add_u32 s26, s5, 8
    s_mov_b32 s51, s3
    s_cmp_ge_u32 s51, 10
    s_cbranch_scc1 TC1_tv
    s_lshl_b32 s51, s51, 6
    v_add_u32 v62, s51, v0
    v_lshrrev_b32 v63, 1, v62
    v_and_b32 v62, 1, v62
    s_mov_b32 s53, 6144
    v_mul_lo_u32 v63, v63, s53
    v_lshl_add_u32 v3, v62, 7, v63
    s_and_b32 s27, s4, 1
    s_mul_i32 s27, s27, 1966080
    s_lshl_b32 s52, s26, 8
    s_add_u32 s27, s27, s52
    s_mov_b32 s52, s34
    s_and_b32 s53, s35, 0xffff
    s_mov_b32 s54, 3932160
    s_mov_b32 s55, 0x00020000
    s_branch TC1_td
TC1_tv:
    s_sub_u32 s51, s51, 10
    s_lshl_b32 s51, s51, 6
    v_add_u32 v62, s51, v0
    v_mul_u32_u24 v63, 171, v62
    v_lshrrev_b32 v63, 10, v63
    v_mul_u32_u24 v64, 6, v63
    v_sub_u32 v62, v62, v64
    s_mov_b32 s53, 3072
    v_mul_lo_u32 v63, v63, s53
    v_lshl_add_u32 v3, v62, 7, v63
    s_lshr_b32 s27, s4, 1
    s_mul_i32 s27, s27, 768
    s_mul_i32 s52, s26, 196608
    s_add_u32 s27, s27, s52
    s_mov_b32 s52, s42
    s_and_b32 s53, s43, 0xffff
    s_mov_b32 s54, 4718592
    s_mov_b32 s55, 0x00020000
TC1_td:
    s_cmp_ge_u32 s3, 4
    s_cselect_b32 s26, 100, s26
    s_mov_b32 s28, 0
    s_mov_b32 s25, 11
    s_cmp_gt_u32 s26, s25
    s_cbranch_scc1 TC1p0_nt
    s_cmp_ge_u32 s26, 24
    s_cbranch_scc1 TC1p0_nt
    buffer_load_dword v2, v3, s[52:55], s27 offen
    s_add_u32 s26, s26, 100
    s_add_u32 s27, s27, s28
TC1p0_nt:
    s_and_b32 s56, s3, 1
    s_lshr_b32 s57, s3, 1
    s_and_b32 s57, s57, 1
    s_lshl_b32 s51, s57, 3
    v_lshlrev_b32 v62, 1, v61
    v_add_u32 v62, s51, v62
    v_xor_b32 v62, v62, v60
    v_lshlrev_b32 v62, 4, v62
    v_lshl_add_u32 v62, v60, 8, v62
    s_lshl_b32 s51, s56, 13
    s_add_u32 s51, s51, 0
    v_add_u32 v5, s51, v62
    v_xor_b32 v6, 16, v5
    v_lshlrev_b32 v4, 2, v0
    s_lshl_b32 s51, s57, 8
    s_add_u32 s51, s51, 143872
    v_add_u32 v4, s51, v4
    v_lshlrev_b32 v9, 6, v61
    v_add_u32 v9, s51, v9
    v_lshrrev_b32 v62, 2, v60
    v_lshl_add_u32 v62, v61, 3, v62
    v_mul_u32_u24 v62, 192, v62
    v_and_b32 v63, 3, v60
    v_lshl_add_u32 v62, v63, 3, v62
    s_mul_i32 s51, s57, 6144
    s_add_u32 s51, s51, 16384
    v_add_u32 v62, s51, v62
    v_and_b32 v63, 1, v61
    v_lshl_add_u32 v10, v63, 5, v62
    v_xor_b32 v63, 1, v63
    v_lshl_add_u32 v11, v63, 5, v62
    v_mov_b32 v100, 0
    v_mov_b32 v101, 0
    v_mov_b32 v102, 0
    v_mov_b32 v103, 0
    v_mov_b32 v104, 0
    v_mov_b32 v105, 0
    v_mov_b32 v106, 0
    v_mov_b32 v107, 0
    v_mov_b32 v108, 0
    v_mov_b32 v109, 0
    v_mov_b32 v110, 0
    v_mov_b32 v111, 0
    v_mov_b32 v112, 0
    v_mov_b32 v113, 0
    v_mov_b32 v114, 0
    v_mov_b32 v115, 0
    v_mov_b32 v116, 0
    v_mov_b32 v117, 0
    v_mov_b32 v118, 0
    v_mov_b32 v119, 0
    v_mov_b32 v120, 0
    v_mov_b32 v121, 0
    v_mov_b32 v122, 0
    v_mov_b32 v123, 0
    v_mov_b32 v124, 0
    v_mov_b32 v125, 0
    v_mov_b32 v126, 0
    v_mov_b32 v127, 0
    v_mov_b32 v128, 0
    v_mov_b32 v129, 0
    v_mov_b32 v130, 0
    v_mov_b32 v131, 0
    v_mov_b32 v132, 0
    v_mov_b32 v133, 0
    v_mov_b32 v134, 0
    v_mov_b32 v135, 0
    v_mov_b32 v136, 0
    v_mov_b32 v137, 0
    v_mov_b32 v138, 0
    v_mov_b32 v139, 0
    v_mov_b32 v140, 0
    v_mov_b32 v141, 0
    v_mov_b32 v142, 0
    v_mov_b32 v143, 0
    v_mov_b32 v144, 0
    v_mov_b32 v145, 0
    v_mov_b32 v146, 0
    v_mov_b32 v147, 0
    v_mov_b32 v76, 0
    v_mov_b32 v77, 0
    v_mov_b32 v78, 0
    v_mov_b32 v79, 0
    v_mov_b32 v80, 0
    v_mov_b32 v81, 0
    v_mov_b32 v82, 0
    v_mov_b32 v83, 0
    v_mov_b32 v84, 0
    v_mov_b32 v85, 0
    v_mov_b32 v86, 0
    v_mov_b32 v87, 0
    v_mov_b32 v88, 0
    v_mov_b32 v89, 0
    v_mov_b32 v90, 0
    v_mov_b32 v91, 0
    v_mov_b32 v92, 0
    v_mov_b32 v93, 0
    v_mov_b32 v94, 0
    v_mov_b32 v95, 0
    v_mov_b32 v96, 0
    v_mov_b32 v97, 0
    v_mov_b32 v98, 0
    v_mov_b32 v99, 0
    v_mov_b32 v34, 0
    v_mov_b32 v35, 0
    v_mov_b32 v36, 0
    v_mov_b32 v37, 0
    v_mov_b32 v38, 0
    v_mov_b32 v39, 0
    v_mov_b32 v40, 0
    v_mov_b32 v41, 0
    v_mov_b32 v43, 0
    s_mov_b32 s30, 28672
    s_mov_b32 s31, 6
    s_barrier
    v_mov_b32 v164, 0
    v_mov_b32 v165, 0
    v_mov_b32 v166, 0
    v_mov_b32 v167, 0
TC1_loop:
    s_barrier
    v_add_u32 v12, s30, v5
    v_add_u32 v13, s30, v6
    v_add_u32 v16, s30, v10
    v_add_u32 v17, s30, v11
    ds_read_b128 v[18:21], v12
    ds_read_b128 v[22:25], v13
    ds_read_b128 v[26:29], v12 offset:4096
    ds_read_b128 v[30:33], v13 offset:4096
    ds_read_b32 v42, v4
    ds_read_b64_tr_b16 v[52:53], v16 offset:0
    v_mfma_f32_16x16x32_bf16 v[124:127], v[164:167], v[76:79], v[124:127]
    ds_read_b64_tr_b16 v[54:55], v16 offset:768
    ds_read_b64_tr_b16 v[56:57], v17 offset:0
    v_mfma_f32_16x16x32_bf16 v[128:131], v[164:167], v[80:83], v[128:131]
    ds_read_b64_tr_b16 v[58:59], v17 offset:768
    ds_read_b64_tr_b16 v[60:61], v16 offset:64
    v_mfma_f32_16x16x32_bf16 v[132:135], v[164:167], v[84:87], v[132:135]
    ds_read_b64_tr_b16 v[62:63], v16 offset:832
    ds_read_b64_tr_b16 v[64:65], v17 offset:64
    v_mfma_f32_16x16x32_bf16 v[136:139], v[164:167], v[88:91], v[136:139]
    ds_read_b64_tr_b16 v[66:67], v17 offset:832
    ds_read_b64_tr_b16 v[68:69], v16 offset:128
    v_mfma_f32_16x16x32_bf16 v[140:143], v[164:167], v[92:95], v[140:143]
    ds_read_b64_tr_b16 v[70:71], v16 offset:896
    ds_read_b64_tr_b16 v[72:73], v17 offset:128
    v_mfma_f32_16x16x32_bf16 v[144:147], v[164:167], v[96:99], v[144:147]
    ds_read_b64_tr_b16 v[74:75], v17 offset:896
    v_add_u32 v4, 1024, v4
    v_add_u32 v9, 1024, v9
    s_add_u32 s30, s30, 57344
    s_cmp_ge_u32 s30, 143360
    s_cselect_b32 s51, 143360, 0
    s_sub_u32 s30, s30, s51
    s_waitcnt lgkmcnt(0)
    s_barrier
    s_add_u32 s25, s25, 2
    s_cmp_gt_u32 s26, s25
    s_cbranch_scc1 TC1la_nt
    s_cmp_ge_u32 s26, 24
    s_cbranch_scc1 TC1la_nt
    buffer_load_dword v2, v3, s[52:55], s27 offen
    s_add_u32 s26, s26, 100
    s_add_u32 s27, s27, s28
TC1la_nt:
    v_cvt_f32_i32 v18, v18
    v_cvt_f32_i32 v19, v19
    v_cvt_f32_i32 v20, v20
    v_cvt_f32_i32 v21, v21
    v_cvt_f32_i32 v22, v22
    v_cvt_f32_i32 v23, v23
    v_cvt_f32_i32 v24, v24
    v_cvt_f32_i32 v25, v25
    v_add_f32_dpp v18, v42, v18 row_newbcast:0 row_mask:0xf bank_mask:0xf
    v_add_f32_dpp v19, v42, v19 row_newbcast:1 row_mask:0xf bank_mask:0xf
    v_add_f32_dpp v20, v42, v20 row_newbcast:2 row_mask:0xf bank_mask:0xf
    v_add_f32_dpp v21, v42, v21 row_newbcast:3 row_mask:0xf bank_mask:0xf
    v_add_f32_dpp v22, v42, v22 row_newbcast:4 row_mask:0xf bank_mask:0xf
    v_add_f32_dpp v23, v42, v23 row_newbcast:5 row_mask:0xf bank_mask:0xf
    v_add_f32_dpp v24, v42, v24 row_newbcast:6 row_mask:0xf bank_mask:0xf
    v_add_f32_dpp v25, v42, v25 row_newbcast:7 row_mask:0xf bank_mask:0xf
    v_cvt_pk_bf16_f32 v44, v18, v19
    v_cvt_pk_bf16_f32 v45, v20, v21
    v_cvt_pk_bf16_f32 v46, v22, v23
    v_cvt_pk_bf16_f32 v47, v24, v25
    v_lshlrev_b32 v18, 16, v44
    v_and_b32 v19, 0xffff0000, v44
    v_lshlrev_b32 v20, 16, v45
    v_and_b32 v21, 0xffff0000, v45
    v_lshlrev_b32 v22, 16, v46
    v_and_b32 v23, 0xffff0000, v46
    v_lshlrev_b32 v24, 16, v47
    v_and_b32 v25, 0xffff0000, v47
    v_mul_f32_dpp v18, v42, v18 row_newbcast:8 row_mask:0xf bank_mask:0xf
    v_mul_f32_dpp v19, v42, v19 row_newbcast:9 row_mask:0xf bank_mask:0xf
    v_mul_f32_dpp v20, v42, v20 row_newbcast:10 row_mask:0xf bank_mask:0xf
    v_mul_f32_dpp v21, v42, v21 row_newbcast:11 row_mask:0xf bank_mask:0xf
    v_mul_f32_dpp v22, v42, v22 row_newbcast:12 row_mask:0xf bank_mask:0xf
    v_mul_f32_dpp v23, v42, v23 row_newbcast:13 row_mask:0xf bank_mask:0xf
    v_mul_f32_dpp v24, v42, v24 row_newbcast:14 row_mask:0xf bank_mask:0xf
    v_mul_f32_dpp v25, v42, v25 row_newbcast:15 row_mask:0xf bank_mask:0xf
    v_cvt_pk_bf16_f32 v48, v18, v19
    v_cvt_pk_bf16_f32 v49, v20, v21
    v_cvt_pk_bf16_f32 v50, v22, v23
    v_cvt_pk_bf16_f32 v51, v24, v25
    v_cvt_f32_i32 v26, v26
    v_cvt_f32_i32 v27, v27
    v_mfma_f32_16x16x32_bf16 v[100:103], v[48:51], v[52:55], v[100:103]
    v_cvt_f32_i32 v28, v28
    v_cvt_f32_i32 v29, v29
    v_cvt_f32_i32 v30, v30
    v_cvt_f32_i32 v31, v31
    v_cvt_f32_i32 v32, v32
    v_cvt_f32_i32 v33, v33
    v_add_f32_dpp v26, v42, v26 row_newbcast:0 row_mask:0xf bank_mask:0xf
    v_mfma_f32_16x16x32_bf16 v[104:107], v[48:51], v[56:59], v[104:107]
    v_add_f32_dpp v27, v42, v27 row_newbcast:1 row_mask:0xf bank_mask:0xf
    v_add_f32_dpp v28, v42, v28 row_newbcast:2 row_mask:0xf bank_mask:0xf
    v_add_f32_dpp v29, v42, v29 row_newbcast:3 row_mask:0xf bank_mask:0xf
    v_add_f32_dpp v30, v42, v30 row_newbcast:4 row_mask:0xf bank_mask:0xf
    v_add_f32_dpp v31, v42, v31 row_newbcast:5 row_mask:0xf bank_mask:0xf
    v_add_f32_dpp v32, v42, v32 row_newbcast:6 row_mask:0xf bank_mask:0xf
    v_add_f32_dpp v33, v42, v33 row_newbcast:7 row_mask:0xf bank_mask:0xf
    v_mfma_f32_16x16x32_bf16 v[108:111], v[48:51], v[60:63], v[108:111]
    v_cvt_pk_bf16_f32 v44, v26, v27
    v_cvt_pk_bf16_f32 v45, v28, v29
    v_cvt_pk_bf16_f32 v46, v30, v31
    v_cvt_pk_bf16_f32 v47, v32, v33
    v_lshlrev_b32 v26, 16, v44
    v_and_b32 v27, 0xffff0000, v44
    v_lshlrev_b32 v28, 16, v45
    v_mfma_f32_16x16x32_bf16 v[112:115], v[48:51], v[64:67], v[112:115]
    v_and_b32 v29, 0xffff0000, v45
    v_lshlrev_b32 v30, 16, v46
    v_and_b32 v31, 0xffff0000, v46
    v_lshlrev_b32 v32, 16, v47
    v_and_b32 v33, 0xffff0000, v47
    v_mul_f32_dpp v26, v42, v26 row_newbcast:8 row_mask:0xf bank_mask:0xf
    v_mul_f32_dpp v27, v42, v27 row_newbcast:9 row_mask:0xf bank_mask:0xf
    v_mfma_f32_16x16x32_bf16 v[116:119], v[48:51], v[68:71], v[116:119]
    v_mul_f32_dpp v28, v42, v28 row_newbcast:10 row_mask:0xf bank_mask:0xf
    v_mul_f32_dpp v29, v42, v29 row_newbcast:11 row_mask:0xf bank_mask:0xf
    v_mul_f32_dpp v30, v42, v30 row_newbcast:12 row_mask:0xf bank_mask:0xf
    v_mul_f32_dpp v31, v42, v31 row_newbcast:13 row_mask:0xf bank_mask:0xf
    v_mul_f32_dpp v32, v42, v32 row_newbcast:14 row_mask:0xf bank_mask:0xf
    v_mul_f32_dpp v33, v42, v33 row_newbcast:15 row_mask:0xf bank_mask:0xf
    v_cvt_pk_bf16_f32 v164, v26, v27
    v_mfma_f32_16x16x32_bf16 v[120:123], v[48:51], v[72:75], v[120:123]
    v_cvt_pk_bf16_f32 v165, v28, v29
    v_cvt_pk_bf16_f32 v166, v30, v31
    v_cvt_pk_bf16_f32 v167, v32, v33
    s_barrier
    v_add_u32 v12, s30, v5
    v_add_u32 v13, s30, v6
    v_add_u32 v16, s30, v10
    v_add_u32 v17, s30, v11
    ds_read_b128 v[18:21], v12
    ds_read_b128 v[22:25], v13
    ds_read_b128 v[34:37], v12 offset:4096
    ds_read_b128 v[38:41], v13 offset:4096
    ds_read_b32 v43, v4
    ds_read_b64_tr_b16 v[76:77], v16 offset:0
    v_mfma_f32_16x16x32_bf16 v[124:127], v[164:167], v[52:55], v[124:127]
    ds_read_b64_tr_b16 v[78:79], v16 offset:768
    ds_read_b64_tr_b16 v[80:81], v17 offset:0
    v_mfma_f32_16x16x32_bf16 v[128:131], v[164:167], v[56:59], v[128:131]
    ds_read_b64_tr_b16 v[82:83], v17 offset:768
    ds_read_b64_tr_b16 v[84:85], v16 offset:64
    v_mfma_f32_16x16x32_bf16 v[132:135], v[164:167], v[60:63], v[132:135]
    ds_read_b64_tr_b16 v[86:87], v16 offset:832
    ds_read_b64_tr_b16 v[88:89], v17 offset:64
    v_mfma_f32_16x16x32_bf16 v[136:139], v[164:167], v[64:67], v[136:139]
    ds_read_b64_tr_b16 v[90:91], v17 offset:832
    ds_read_b64_tr_b16 v[92:93], v16 offset:128
    v_mfma_f32_16x16x32_bf16 v[140:143], v[164:167], v[68:71], v[140:143]
    ds_read_b64_tr_b16 v[94:95], v16 offset:896
    ds_read_b64_tr_b16 v[96:97], v17 offset:128
    v_mfma_f32_16x16x32_bf16 v[144:147], v[164:167], v[72:75], v[144:147]
    ds_read_b64_tr_b16 v[98:99], v17 offset:896
    v_add_u32 v4, 1024, v4
    v_add_u32 v9, 1024, v9
    s_add_u32 s30, s30, 57344
    s_cmp_ge_u32 s30, 143360
    s_cselect_b32 s51, 143360, 0
    s_sub_u32 s30, s30, s51
    s_waitcnt lgkmcnt(0)
    s_barrier
    s_add_u32 s25, s25, 2
    s_cmp_gt_u32 s26, s25
    s_cbranch_scc1 TC1lb_nt
    s_cmp_ge_u32 s26, 24
    s_cbranch_scc1 TC1lb_nt
    buffer_load_dword v2, v3, s[52:55], s27 offen
    s_add_u32 s26, s26, 100
    s_add_u32 s27, s27, s28
TC1lb_nt:
    v_cvt_f32_i32 v18, v18
    v_cvt_f32_i32 v19, v19
    v_cvt_f32_i32 v20, v20
    v_cvt_f32_i32 v21, v21
    v_cvt_f32_i32 v22, v22
    v_cvt_f32_i32 v23, v23
    v_cvt_f32_i32 v24, v24
    v_cvt_f32_i32 v25, v25
    v_add_f32_dpp v18, v43, v18 row_newbcast:0 row_mask:0xf bank_mask:0xf
    v_add_f32_dpp v19, v43, v19 row_newbcast:1 row_mask:0xf bank_mask:0xf
    v_add_f32_dpp v20, v43, v20 row_newbcast:2 row_mask:0xf bank_mask:0xf
    v_add_f32_dpp v21, v43, v21 row_newbcast:3 row_mask:0xf bank_mask:0xf
    v_add_f32_dpp v22, v43, v22 row_newbcast:4 row_mask:0xf bank_mask:0xf
    v_add_f32_dpp v23, v43, v23 row_newbcast:5 row_mask:0xf bank_mask:0xf
    v_add_f32_dpp v24, v43, v24 row_newbcast:6 row_mask:0xf bank_mask:0xf
    v_add_f32_dpp v25, v43, v25 row_newbcast:7 row_mask:0xf bank_mask:0xf
    v_cvt_pk_bf16_f32 v44, v18, v19
    v_cvt_pk_bf16_f32 v45, v20, v21
    v_cvt_pk_bf16_f32 v46, v22, v23
    v_cvt_pk_bf16_f32 v47, v24, v25
    v_lshlrev_b32 v18, 16, v44
    v_and_b32 v19, 0xffff0000, v44
    v_lshlrev_b32 v20, 16, v45
    v_and_b32 v21, 0xffff0000, v45
    v_lshlrev_b32 v22, 16, v46
    v_and_b32 v23, 0xffff0000, v46
    v_lshlrev_b32 v24, 16, v47
    v_and_b32 v25, 0xffff0000, v47
    v_mul_f32_dpp v18, v43, v18 row_newbcast:8 row_mask:0xf bank_mask:0xf
    v_mul_f32_dpp v19, v43, v19 row_newbcast:9 row_mask:0xf bank_mask:0xf
    v_mul_f32_dpp v20, v43, v20 row_newbcast:10 row_mask:0xf bank_mask:0xf
    v_mul_f32_dpp v21, v43, v21 row_newbcast:11 row_mask:0xf bank_mask:0xf
    v_mul_f32_dpp v22, v43, v22 row_newbcast:12 row_mask:0xf bank_mask:0xf
    v_mul_f32_dpp v23, v43, v23 row_newbcast:13 row_mask:0xf bank_mask:0xf
    v_mul_f32_dpp v24, v43, v24 row_newbcast:14 row_mask:0xf bank_mask:0xf
    v_mul_f32_dpp v25, v43, v25 row_newbcast:15 row_mask:0xf bank_mask:0xf
    v_cvt_pk_bf16_f32 v48, v18, v19
    v_cvt_pk_bf16_f32 v49, v20, v21
    v_cvt_pk_bf16_f32 v50, v22, v23
    v_cvt_pk_bf16_f32 v51, v24, v25
    v_cvt_f32_i32 v34, v34
    v_cvt_f32_i32 v35, v35
    v_mfma_f32_16x16x32_bf16 v[100:103], v[48:51], v[76:79], v[100:103]
    v_cvt_f32_i32 v36, v36
    v_cvt_f32_i32 v37, v37
    v_cvt_f32_i32 v38, v38
    v_cvt_f32_i32 v39, v39
    v_cvt_f32_i32 v40, v40
    v_cvt_f32_i32 v41, v41
    v_add_f32_dpp v34, v43, v34 row_newbcast:0 row_mask:0xf bank_mask:0xf
    v_mfma_f32_16x16x32_bf16 v[104:107], v[48:51], v[80:83], v[104:107]
    v_add_f32_dpp v35, v43, v35 row_newbcast:1 row_mask:0xf bank_mask:0xf
    v_add_f32_dpp v36, v43, v36 row_newbcast:2 row_mask:0xf bank_mask:0xf
    v_add_f32_dpp v37, v43, v37 row_newbcast:3 row_mask:0xf bank_mask:0xf
    v_add_f32_dpp v38, v43, v38 row_newbcast:4 row_mask:0xf bank_mask:0xf
    v_add_f32_dpp v39, v43, v39 row_newbcast:5 row_mask:0xf bank_mask:0xf
    v_add_f32_dpp v40, v43, v40 row_newbcast:6 row_mask:0xf bank_mask:0xf
    v_add_f32_dpp v41, v43, v41 row_newbcast:7 row_mask:0xf bank_mask:0xf
    v_mfma_f32_16x16x32_bf16 v[108:111], v[48:51], v[84:87], v[108:111]
    v_cvt_pk_bf16_f32 v44, v34, v35
    v_cvt_pk_bf16_f32 v45, v36, v37
    v_cvt_pk_bf16_f32 v46, v38, v39
    v_cvt_pk_bf16_f32 v47, v40, v41
    v_lshlrev_b32 v34, 16, v44
    v_and_b32 v35, 0xffff0000, v44
    v_lshlrev_b32 v36, 16, v45
    v_mfma_f32_16x16x32_bf16 v[112:115], v[48:51], v[88:91], v[112:115]
    v_and_b32 v37, 0xffff0000, v45
    v_lshlrev_b32 v38, 16, v46
    v_and_b32 v39, 0xffff0000, v46
    v_lshlrev_b32 v40, 16, v47
    v_and_b32 v41, 0xffff0000, v47
    v_mul_f32_dpp v34, v43, v34 row_newbcast:8 row_mask:0xf bank_mask:0xf
    v_mul_f32_dpp v35, v43, v35 row_newbcast:9 row_mask:0xf bank_mask:0xf
    v_mfma_f32_16x16x32_bf16 v[116:119], v[48:51], v[92:95], v[116:119]
    v_mul_f32_dpp v36, v43, v36 row_newbcast:10 row_mask:0xf bank_mask:0xf
    v_mul_f32_dpp v37, v43, v37 row_newbcast:11 row_mask:0xf bank_mask:0xf
    v_mul_f32_dpp v38, v43, v38 row_newbcast:12 row_mask:0xf bank_mask:0xf
    v_mul_f32_dpp v39, v43, v39 row_newbcast:13 row_mask:0xf bank_mask:0xf
    v_mul_f32_dpp v40, v43, v40 row_newbcast:14 row_mask:0xf bank_mask:0xf
    v_mul_f32_dpp v41, v43, v41 row_newbcast:15 row_mask:0xf bank_mask:0xf
    v_cvt_pk_bf16_f32 v164, v34, v35
    v_mfma_f32_16x16x32_bf16 v[120:123], v[48:51], v[96:99], v[120:123]
    v_cvt_pk_bf16_f32 v165, v36, v37
    v_cvt_pk_bf16_f32 v166, v38, v39
    v_cvt_pk_bf16_f32 v167, v40, v41
    s_sub_u32 s31, s31, 1
    s_cmp_lg_u32 s31, 0
    s_cbranch_scc1 TC1_loop
    s_nop 1
    v_mfma_f32_16x16x32_bf16 v[124:127], v[164:167], v[76:79], v[124:127]
    v_mfma_f32_16x16x32_bf16 v[128:131], v[164:167], v[80:83], v[128:131]
    v_mfma_f32_16x16x32_bf16 v[132:135], v[164:167], v[84:87], v[132:135]
    v_mfma_f32_16x16x32_bf16 v[136:139], v[164:167], v[88:91], v[136:139]
    v_mfma_f32_16x16x32_bf16 v[140:143], v[164:167], v[92:95], v[140:143]
    v_mfma_f32_16x16x32_bf16 v[144:147], v[164:167], v[96:99], v[144:147]
    s_mul_i32 s51, s56, 49152
    s_mul_i32 s52, s57, 12288
    s_add_u32 s51, s51, s52
    s_add_u32 s51, s51, 24576
    v_lshlrev_b32 v15, 4, v0
    v_add_u32 v14, s51, v15
    s_mul_i32 s51, s56, 49152
    v_add_u32 v13, s51, v15
    s_nop 7
    s_cmp_eq_u32 s57, 1
    s_cbranch_scc1 TC1_ep1
    ds_write_b128 v14, v[100:103] offset:0
    ds_write_b128 v14, v[104:107] offset:1024
    ds_write_b128 v14, v[108:111] offset:2048
    ds_write_b128 v14, v[112:115] offset:3072
    ds_write_b128 v14, v[124:127] offset:6144
    ds_write_b128 v14, v[128:131] offset:7168
    ds_write_b128 v14, v[132:135] offset:8192
    ds_write_b128 v14, v[136:139] offset:9216
    s_lshl_b32 s51, s6, 1
    s_add_u32 s51, s51, s56
    s_mul_i32 s54, s7, 120
    s_add_u32 s54, s54, s51
    s_add_u32 s54, s54, 80
    s_lshl_b32 s54, s54, 10
    s_add_u32 s54, s54, 2621440
    s_add_u32 s55, s54, 20480
    s_waitcnt lgkmcnt(0)
    s_barrier
    ds_read_b128 v[20:23], v13 offset:4096
    ds_read_b128 v[24:27], v13 offset:16384
    ds_read_b128 v[28:31], v13 offset:40960
    ds_read_b128 v[32:35], v13 offset:10240
    ds_read_b128 v[36:39], v13 offset:22528
    ds_read_b128 v[40:43], v13 offset:47104
    ds_read_b128 v[44:47], v13 offset:5120
    ds_read_b128 v[48:51], v13 offset:17408
    ds_read_b128 v[52:55], v13 offset:41984
    ds_read_b128 v[56:59], v13 offset:11264
    ds_read_b128 v[60:63], v13 offset:23552
    ds_read_b128 v[64:67], v13 offset:48128
    s_waitcnt lgkmcnt(9)
    v_add_f32 v116, v116, v20
    v_add_f32 v117, v117, v21
    v_add_f32 v118, v118, v22
    v_add_f32 v119, v119, v23
    v_add_f32 v116, v116, v24
    v_add_f32 v117, v117, v25
    v_add_f32 v118, v118, v26
    v_add_f32 v119, v119, v27
    v_add_f32 v116, v116, v28
    v_add_f32 v117, v117, v29
    v_add_f32 v118, v118, v30
    v_add_f32 v119, v119, v31
    v_cvt_pk_bf16_f32 v72, v116, v117
    v_cvt_pk_bf16_f32 v73, v118, v119
    s_waitcnt lgkmcnt(6)
    v_add_f32 v140, v140, v32
    v_add_f32 v141, v141, v33
    v_add_f32 v142, v142, v34
    v_add_f32 v143, v143, v35
    v_add_f32 v140, v140, v36
    v_add_f32 v141, v141, v37
    v_add_f32 v142, v142, v38
    v_add_f32 v143, v143, v39
    v_add_f32 v140, v140, v40
    v_add_f32 v141, v141, v41
    v_add_f32 v142, v142, v42
    v_add_f32 v143, v143, v43
    v_cvt_pk_bf16_f32 v74, v140, v141
    v_cvt_pk_bf16_f32 v75, v142, v143
    buffer_store_dwordx4 v[72:75], v15, s[16:19], s54 offen sc1
    s_waitcnt lgkmcnt(3)
    v_add_f32 v120, v120, v44
    v_add_f32 v121, v121, v45
    v_add_f32 v122, v122, v46
    v_add_f32 v123, v123, v47
    v_add_f32 v120, v120, v48
    v_add_f32 v121, v121, v49
    v_add_f32 v122, v122, v50
    v_add_f32 v123, v123, v51
    v_add_f32 v120, v120, v52
    v_add_f32 v121, v121, v53
    v_add_f32 v122, v122, v54
    v_add_f32 v123, v123, v55
    v_cvt_pk_bf16_f32 v76, v120, v121
    v_cvt_pk_bf16_f32 v77, v122, v123
    s_waitcnt lgkmcnt(0)
    v_add_f32 v144, v144, v56
    v_add_f32 v145, v145, v57
    v_add_f32 v146, v146, v58
    v_add_f32 v147, v147, v59
    v_add_f32 v144, v144, v60
    v_add_f32 v145, v145, v61
    v_add_f32 v146, v146, v62
    v_add_f32 v147, v147, v63
    v_add_f32 v144, v144, v64
    v_add_f32 v145, v145, v65
    v_add_f32 v146, v146, v66
    v_add_f32 v147, v147, v67
    v_cvt_pk_bf16_f32 v78, v144, v145
    v_cvt_pk_bf16_f32 v79, v146, v147
    buffer_store_dwordx4 v[76:79], v15, s[16:19], s55 offen sc1
    s_endpgm
TC1_ep1:
    ds_write_b128 v14, v[100:103] offset:0
    ds_write_b128 v14, v[104:107] offset:1024
    ds_write_b128 v14, v[108:111] offset:2048
    ds_write_b128 v14, v[112:115] offset:3072
    ds_write_b128 v14, v[116:119] offset:4096
    ds_write_b128 v14, v[120:123] offset:5120
    ds_write_b128 v14, v[124:127] offset:6144
    ds_write_b128 v14, v[128:131] offset:7168
    ds_write_b128 v14, v[132:135] offset:8192
    ds_write_b128 v14, v[136:139] offset:9216
    ds_write_b128 v14, v[140:143] offset:10240
    ds_write_b128 v14, v[144:147] offset:11264
    s_waitcnt lgkmcnt(0)
    s_barrier
    s_endpgm
P1_x:
    s_sub_u32 s5, s5, 20
    s_cmp_ge_u32 s5, 5
    s_cselect_b32 s51, 1, 0
    s_mul_i32 s52, s51, 5
    s_sub_u32 s6, s5, s52
    s_lshl_b32 s7, s4, 1
    s_add_u32 s7, s7, s51
    v_and_b32 v60, 15, v0
    v_lshrrev_b32 v61, 4, v0
    s_and_b32 s56, s3, 1
    s_lshr_b32 s57, s3, 1
    v_lshrrev_b32 v62, 2, v60
    v_and_b32 v63, 1, v61
    v_lshl_add_u32 v63, v63, 2, v62
    v_lshl_add_u32 v62, v61, 3, v62
    v_lshlrev_b32 v62, 8, v62
    v_and_b32 v64, 3, v60
    v_lshl_add_u32 v62, v64, 3, v62
    s_lshl_b32 s51, s56, 2
    s_add_u32 s58, s51, 0
    v_xor_b32 v64, s58, v63
    v_lshl_add_u32 v5, v64, 5, v62
    s_add_u32 s58, s51, 1
    v_xor_b32 v64, s58, v63
    v_lshl_add_u32 v6, v64, 5, v62
    s_add_u32 s58, s51, 2
    v_xor_b32 v64, s58, v63
    v_lshl_add_u32 v7, v64, 5, v62
    s_add_u32 s58, s51, 3
    v_xor_b32 v64, s58, v63
    v_lshl_add_u32 v8, v64, 5, v62
    v_lshrrev_b32 v62, 1, v60
    v_xor_b32 v62, v62, v61
    v_lshlrev_b32 v62, 4, v62
    v_lshl_add_u32 v62, v60, 7, v62
    s_lshl_b32 s51, s57, 12
    s_add_u32 s51, s51, 16384
    v_add_u32 v9, s51, v62
    v_xor_b32 v10, 64, v9
    v_mov_b32 v96, 0
    v_mov_b32 v97, 0
    v_mov_b32 v98, 0
    v_mov_b32 v99, 0
    v_mov_b32 v100, 0
    v_mov_b32 v101, 0
    v_mov_b32 v102, 0
    v_mov_b32 v103, 0
    v_mov_b32 v104, 0
    v_mov_b32 v105, 0
    v_mov_b32 v106, 0
    v_mov_b32 v107, 0
    v_mov_b32 v108, 0
    v_mov_b32 v109, 0
    v_mov_b32 v110, 0
    v_mov_b32 v111, 0
    v_mov_b32 v112, 0
    v_mov_b32 v113, 0
    v_mov_b32 v114, 0
    v_mov_b32 v115, 0
    v_mov_b32 v116, 0
    v_mov_b32 v117, 0
    v_mov_b32 v118, 0
    v_mov_b32 v119, 0
    v_mov_b32 v120, 0
    v_mov_b32 v121, 0
    v_mov_b32 v122, 0
    v_mov_b32 v123, 0
    v_mov_b32 v124, 0
    v_mov_b32 v125, 0
    v_mov_b32 v126, 0
    v_mov_b32 v127, 0
    s_mov_b32 s30, 0
    s_mov_b32 s31, 10
    s_mov_b32 s24, s5
    s_mov_b32 s25, 0
    s_barrier
    s_and_b32 s51, s25, 7
    s_cmp_lg_u32 s51, s3
    s_cbranch_scc1 XCa_nt0
    s_mul_i32 s26, s24, 513
    s_lshr_b32 s26, s26, 12
    s_mul_i32 s51, s26, 8
    s_sub_u32 s51, s24, s51
    s_add_u32 s51, s51, 4
    s_add_u32 s26, s26, 8
    s_cmp_ge_u32 s26, 24
    s_cbranch_scc1 XCa_nt0
    s_cmp_ge_u32 s51, 10
    s_cbranch_scc1 XCax0_tv
    s_lshl_b32 s51, s51, 6
    v_add_u32 v20, s51, v0
    v_lshrrev_b32 v21, 1, v20
    v_and_b32 v20, 1, v20
    s_mov_b32 s53, 6144
    v_mul_lo_u32 v21, v21, s53
    v_lshl_add_u32 v3, v20, 7, v21
    s_and_b32 s27, s4, 1
    s_mul_i32 s27, s27, 1966080
    s_lshl_b32 s52, s26, 8
    s_add_u32 s27, s27, s52
    s_mov_b32 s52, s34
    s_and_b32 s53, s35, 0xffff
    s_mov_b32 s54, 3932160
    s_mov_b32 s55, 0x00020000
    s_branch XCax0_td
XCax0_tv:
    s_sub_u32 s51, s51, 10
    s_lshl_b32 s51, s51, 6
    v_add_u32 v20, s51, v0
    v_mul_u32_u24 v21, 171, v20
    v_lshrrev_b32 v21, 10, v21
    v_mul_u32_u24 v22, 6, v21
    v_sub_u32 v20, v20, v22
    s_mov_b32 s53, 3072
    v_mul_lo_u32 v21, v21, s53
    v_lshl_add_u32 v3, v20, 7, v21
    s_lshr_b32 s27, s4, 1
    s_mul_i32 s27, s27, 768
    s_mul_i32 s52, s26, 196608
    s_add_u32 s27, s27, s52
    s_mov_b32 s52, s42
    s_and_b32 s53, s43, 0xffff
    s_mov_b32 s54, 4718592
    s_mov_b32 s55, 0x00020000
XCax0_td:
    buffer_load_dword v2, v3, s[52:55], s27 offen
XCa_nt0:
    s_add_u32 s24, s24, 10
    s_add_u32 s25, s25, 1
    s_and_b32 s51, s25, 7
    s_cmp_lg_u32 s51, s3
    s_cbranch_scc1 XCa_nt1
    s_mul_i32 s26, s24, 513
    s_lshr_b32 s26, s26, 12
    s_mul_i32 s51, s26, 8
    s_sub_u32 s51, s24, s51
    s_add_u32 s51, s51, 4
    s_add_u32 s26, s26, 8
    s_cmp_ge_u32 s26, 24
    s_cbranch_scc1 XCa_nt1
    s_cmp_ge_u32 s51, 10
    s_cbranch_scc1 XCax1_tv
    s_lshl_b32 s51, s51, 6
    v_add_u32 v20, s51, v0
    v_lshrrev_b32 v21, 1, v20
    v_and_b32 v20, 1, v20
    s_mov_b32 s53, 6144
    v_mul_lo_u32 v21, v21, s53
    v_lshl_add_u32 v3, v20, 7, v21
    s_and_b32 s27, s4, 1
    s_mul_i32 s27, s27, 1966080
    s_lshl_b32 s52, s26, 8
    s_add_u32 s27, s27, s52
    s_mov_b32 s52, s34
    s_and_b32 s53, s35, 0xffff
    s_mov_b32 s54, 3932160
    s_mov_b32 s55, 0x00020000
    s_branch XCax1_td
XCax1_tv:
    s_sub_u32 s51, s51, 10
    s_lshl_b32 s51, s51, 6
    v_add_u32 v20, s51, v0
    v_mul_u32_u24 v21, 171, v20
    v_lshrrev_b32 v21, 10, v21
    v_mul_u32_u24 v22, 6, v21
    v_sub_u32 v20, v20, v22
    s_mov_b32 s53, 3072
    v_mul_lo_u32 v21, v21, s53
    v_lshl_add_u32 v3, v20, 7, v21
    s_lshr_b32 s27, s4, 1
    s_mul_i32 s27, s27, 768
    s_mul_i32 s52, s26, 196608
    s_add_u32 s27, s27, s52
    s_mov_b32 s52, s42
    s_and_b32 s53, s43, 0xffff
    s_mov_b32 s54, 4718592
    s_mov_b32 s55, 0x00020000
XCax1_td:
    buffer_load_dword v2, v3, s[52:55], s27 offen
XCa_nt1:
    s_add_u32 s24, s24, 10
    s_add_u32 s25, s25, 1
    s_and_b32 s51, s25, 7
    s_cmp_lg_u32 s51, s3
    s_cbranch_scc1 XCa_nt2
    s_mul_i32 s26, s24, 513
    s_lshr_b32 s26, s26, 12
    s_mul_i32 s51, s26, 8
    s_sub_u32 s51, s24, s51
    s_add_u32 s51, s51, 4
    s_add_u32 s26, s26, 8
    s_cmp_ge_u32 s26, 24
    s_cbranch_scc1 XCa_nt2
    s_cmp_ge_u32 s51, 10
    s_cbranch_scc1 XCax2_tv
    s_lshl_b32 s51, s51, 6
    v_add_u32 v20, s51, v0
    v_lshrrev_b32 v21, 1, v20
    v_and_b32 v20, 1, v20
    s_mov_b32 s53, 6144
    v_mul_lo_u32 v21, v21, s53
    v_lshl_add_u32 v3, v20, 7, v21
    s_and_b32 s27, s4, 1
    s_mul_i32 s27, s27, 1966080
    s_lshl_b32 s52, s26, 8
    s_add_u32 s27, s27, s52
    s_mov_b32 s52, s34
    s_and_b32 s53, s35, 0xffff
    s_mov_b32 s54, 3932160
    s_mov_b32 s55, 0x00020000
    s_branch XCax2_td
XCax2_tv:
    s_sub_u32 s51, s51, 10
    s_lshl_b32 s51, s51, 6
    v_add_u32 v20, s51, v0
    v_mul_u32_u24 v21, 171, v20
    v_lshrrev_b32 v21, 10, v21
    v_mul_u32_u24 v22, 6, v21
    v_sub_u32 v20, v20, v22
    s_mov_b32 s53, 3072
    v_mul_lo_u32 v21, v21, s53
    v_lshl_add_u32 v3, v20, 7, v21
    s_lshr_b32 s27, s4, 1
    s_mul_i32 s27, s27, 768
    s_mul_i32 s52, s26, 196608
    s_add_u32 s27, s27, s52
    s_mov_b32 s52, s42
    s_and_b32 s53, s43, 0xffff
    s_mov_b32 s54, 4718592
    s_mov_b32 s55, 0x00020000
XCax2_td:
    buffer_load_dword v2, v3, s[52:55], s27 offen
XCa_nt2:
    s_add_u32 s24, s24, 10
    s_add_u32 s25, s25, 1
    v_add_u32 v11, s30, v5
    v_add_u32 v12, s30, v6
    v_add_u32 v13, s30, v7
    v_add_u32 v14, s30, v8
    v_add_u32 v15, s30, v9
    v_add_u32 v16, s30, v10
    s_add_u32 s30, s30, 32768
    s_cmp_ge_u32 s30, 131072
    s_cselect_b32 s30, 0, s30
    ds_read_b128 v[48:51], v15 offset:0
    ds_read_b128 v[52:55], v15 offset:2048
    ds_read_b64_tr_b16 v[32:33], v11 offset:0
    ds_read_b64_tr_b16 v[34:35], v11 offset:1024
    ds_read_b64_tr_b16 v[36:37], v12 offset:0
    ds_read_b64_tr_b16 v[38:39], v12 offset:1024
    ds_read_b64_tr_b16 v[40:41], v13 offset:0
    ds_read_b64_tr_b16 v[42:43], v13 offset:1024
    ds_read_b64_tr_b16 v[44:45], v14 offset:0
    ds_read_b64_tr_b16 v[46:47], v14 offset:1024
    s_mov_b32 s31, 9
XC_loop:
    s_waitcnt lgkmcnt(0)
    v_mfma_f32_16x16x32_bf16 v[96:99], v[32:35], v[48:51], v[96:99]
    ds_read_b128 v[80:83], v16 offset:0
    ds_read_b128 v[84:87], v16 offset:2048
    v_mfma_f32_16x16x32_bf16 v[100:103], v[32:35], v[52:55], v[100:103]
    ds_read_b64_tr_b16 v[64:65], v11 offset:8192
    ds_read_b64_tr_b16 v[66:67], v11 offset:9216
    v_mfma_f32_16x16x32_bf16 v[104:107], v[36:39], v[48:51], v[104:107]
    ds_read_b64_tr_b16 v[68:69], v12 offset:8192
    v_mfma_f32_16x16x32_bf16 v[108:111], v[36:39], v[52:55], v[108:111]
    ds_read_b64_tr_b16 v[70:71], v12 offset:9216
    v_mfma_f32_16x16x32_bf16 v[112:115], v[40:43], v[48:51], v[112:115]
    ds_read_b64_tr_b16 v[72:73], v13 offset:8192
    v_mfma_f32_16x16x32_bf16 v[116:119], v[40:43], v[52:55], v[116:119]
    ds_read_b64_tr_b16 v[74:75], v13 offset:9216
    v_mfma_f32_16x16x32_bf16 v[120:123], v[44:47], v[48:51], v[120:123]
    ds_read_b64_tr_b16 v[76:77], v14 offset:8192
    v_mfma_f32_16x16x32_bf16 v[124:127], v[44:47], v[52:55], v[124:127]
    ds_read_b64_tr_b16 v[78:79], v14 offset:9216
    s_waitcnt lgkmcnt(0)
    s_barrier
    s_and_b32 s51, s25, 7
    s_cmp_lg_u32 s51, s3
    s_cbranch_scc1 XCb_nt0
    s_mul_i32 s26, s24, 513
    s_lshr_b32 s26, s26, 12
    s_mul_i32 s51, s26, 8
    s_sub_u32 s51, s24, s51
    s_add_u32 s51, s51, 4
    s_add_u32 s26, s26, 8
    s_cmp_ge_u32 s26, 24
    s_cbranch_scc1 XCb_nt0
    s_cmp_ge_u32 s51, 10
    s_cbranch_scc1 XCbx0_tv
    s_lshl_b32 s51, s51, 6
    v_add_u32 v20, s51, v0
    v_lshrrev_b32 v21, 1, v20
    v_and_b32 v20, 1, v20
    s_mov_b32 s53, 6144
    v_mul_lo_u32 v21, v21, s53
    v_lshl_add_u32 v3, v20, 7, v21
    s_and_b32 s27, s4, 1
    s_mul_i32 s27, s27, 1966080
    s_lshl_b32 s52, s26, 8
    s_add_u32 s27, s27, s52
    s_mov_b32 s52, s34
    s_and_b32 s53, s35, 0xffff
    s_mov_b32 s54, 3932160
    s_mov_b32 s55, 0x00020000
    s_branch XCbx0_td
XCbx0_tv:
    s_sub_u32 s51, s51, 10
    s_lshl_b32 s51, s51, 6
    v_add_u32 v20, s51, v0
    v_mul_u32_u24 v21, 171, v20
    v_lshrrev_b32 v21, 10, v21
    v_mul_u32_u24 v22, 6, v21
    v_sub_u32 v20, v20, v22
    s_mov_b32 s53, 3072
    v_mul_lo_u32 v21, v21, s53
    v_lshl_add_u32 v3, v20, 7, v21
    s_lshr_b32 s27, s4, 1
    s_mul_i32 s27, s27, 768
    s_mul_i32 s52, s26, 196608
    s_add_u32 s27, s27, s52
    s_mov_b32 s52, s42
    s_and_b32 s53, s43, 0xffff
    s_mov_b32 s54, 4718592
    s_mov_b32 s55, 0x00020000
XCbx0_td:
    buffer_load_dword v2, v3, s[52:55], s27 offen
XCb_nt0:
    s_add_u32 s24, s24, 10
    s_add_u32 s25, s25, 1
    s_and_b32 s51, s25, 7
    s_cmp_lg_u32 s51, s3
    s_cbranch_scc1 XCb_nt1
    s_mul_i32 s26, s24, 513
    s_lshr_b32 s26, s26, 12
    s_mul_i32 s51, s26, 8
    s_sub_u32 s51, s24, s51
    s_add_u32 s51, s51, 4
    s_add_u32 s26, s26, 8
    s_cmp_ge_u32 s26, 24
    s_cbranch_scc1 XCb_nt1
    s_cmp_ge_u32 s51, 10
    s_cbranch_scc1 XCbx1_tv
    s_lshl_b32 s51, s51, 6
    v_add_u32 v20, s51, v0
    v_lshrrev_b32 v21, 1, v20
    v_and_b32 v20, 1, v20
    s_mov_b32 s53, 6144
    v_mul_lo_u32 v21, v21, s53
    v_lshl_add_u32 v3, v20, 7, v21
    s_and_b32 s27, s4, 1
    s_mul_i32 s27, s27, 1966080
    s_lshl_b32 s52, s26, 8
    s_add_u32 s27, s27, s52
    s_mov_b32 s52, s34
    s_and_b32 s53, s35, 0xffff
    s_mov_b32 s54, 3932160
    s_mov_b32 s55, 0x00020000
    s_branch XCbx1_td
XCbx1_tv:
    s_sub_u32 s51, s51, 10
    s_lshl_b32 s51, s51, 6
    v_add_u32 v20, s51, v0
    v_mul_u32_u24 v21, 171, v20
    v_lshrrev_b32 v21, 10, v21
    v_mul_u32_u24 v22, 6, v21
    v_sub_u32 v20, v20, v22
    s_mov_b32 s53, 3072
    v_mul_lo_u32 v21, v21, s53
    v_lshl_add_u32 v3, v20, 7, v21
    s_lshr_b32 s27, s4, 1
    s_mul_i32 s27, s27, 768
    s_mul_i32 s52, s26, 196608
    s_add_u32 s27, s27, s52
    s_mov_b32 s52, s42
    s_and_b32 s53, s43, 0xffff
    s_mov_b32 s54, 4718592
    s_mov_b32 s55, 0x00020000
XCbx1_td:
    buffer_load_dword v2, v3, s[52:55], s27 offen
XCb_nt1:
    s_add_u32 s24, s24, 10
    s_add_u32 s25, s25, 1
    s_and_b32 s51, s25, 7
    s_cmp_lg_u32 s51, s3
    s_cbranch_scc1 XCb_nt2
    s_mul_i32 s26, s24, 513
    s_lshr_b32 s26, s26, 12
    s_mul_i32 s51, s26, 8
    s_sub_u32 s51, s24, s51
    s_add_u32 s51, s51, 4
    s_add_u32 s26, s26, 8
    s_cmp_ge_u32 s26, 24
    s_cbranch_scc1 XCb_nt2
    s_cmp_ge_u32 s51, 10
    s_cbranch_scc1 XCbx2_tv
    s_lshl_b32 s51, s51, 6
    v_add_u32 v20, s51, v0
    v_lshrrev_b32 v21, 1, v20
    v_and_b32 v20, 1, v20
    s_mov_b32 s53, 6144
    v_mul_lo_u32 v21, v21, s53
    v_lshl_add_u32 v3, v20, 7, v21
    s_and_b32 s27, s4, 1
    s_mul_i32 s27, s27, 1966080
    s_lshl_b32 s52, s26, 8
    s_add_u32 s27, s27, s52
    s_mov_b32 s52, s34
    s_and_b32 s53, s35, 0xffff
    s_mov_b32 s54, 3932160
    s_mov_b32 s55, 0x00020000
    s_branch XCbx2_td
XCbx2_tv:
    s_sub_u32 s51, s51, 10
    s_lshl_b32 s51, s51, 6
    v_add_u32 v20, s51, v0
    v_mul_u32_u24 v21, 171, v20
    v_lshrrev_b32 v21, 10, v21
    v_mul_u32_u24 v22, 6, v21
    v_sub_u32 v20, v20, v22
    s_mov_b32 s53, 3072
    v_mul_lo_u32 v21, v21, s53
    v_lshl_add_u32 v3, v20, 7, v21
    s_lshr_b32 s27, s4, 1
    s_mul_i32 s27, s27, 768
    s_mul_i32 s52, s26, 196608
    s_add_u32 s27, s27, s52
    s_mov_b32 s52, s42
    s_and_b32 s53, s43, 0xffff
    s_mov_b32 s54, 4718592
    s_mov_b32 s55, 0x00020000
XCbx2_td:
    buffer_load_dword v2, v3, s[52:55], s27 offen
XCb_nt2:
    s_add_u32 s24, s24, 10
    s_add_u32 s25, s25, 1
    v_add_u32 v11, s30, v5
    v_add_u32 v12, s30, v6
    v_add_u32 v13, s30, v7
    v_add_u32 v14, s30, v8
    v_add_u32 v15, s30, v9
    v_add_u32 v16, s30, v10
    s_add_u32 s30, s30, 32768
    s_cmp_ge_u32 s30, 131072
    s_cselect_b32 s30, 0, s30
    v_mfma_f32_16x16x32_bf16 v[96:99], v[64:67], v[80:83], v[96:99]
    ds_read_b128 v[48:51], v15 offset:0
    ds_read_b128 v[52:55], v15 offset:2048
    v_mfma_f32_16x16x32_bf16 v[100:103], v[64:67], v[84:87], v[100:103]
    ds_read_b64_tr_b16 v[32:33], v11 offset:0
    ds_read_b64_tr_b16 v[34:35], v11 offset:1024
    v_mfma_f32_16x16x32_bf16 v[104:107], v[68:71], v[80:83], v[104:107]
    ds_read_b64_tr_b16 v[36:37], v12 offset:0
    v_mfma_f32_16x16x32_bf16 v[108:111], v[68:71], v[84:87], v[108:111]
    ds_read_b64_tr_b16 v[38:39], v12 offset:1024
    v_mfma_f32_16x16x32_bf16 v[112:115], v[72:75], v[80:83], v[112:115]
    ds_read_b64_tr_b16 v[40:41], v13 offset:0
    v_mfma_f32_16x16x32_bf16 v[116:119], v[72:75], v[84:87], v[116:119]
    ds_read_b64_tr_b16 v[42:43], v13 offset:1024
    v_mfma_f32_16x16x32_bf16 v[120:123], v[76:79], v[80:83], v[120:123]
    ds_read_b64_tr_b16 v[44:45], v14 offset:0
    v_mfma_f32_16x16x32_bf16 v[124:127], v[76:79], v[84:87], v[124:127]
    ds_read_b64_tr_b16 v[46:47], v14 offset:1024
    s_sub_u32 s31, s31, 1
    s_cmp_lg_u32 s31, 0
    s_cbranch_scc1 XC_loop
    s_waitcnt lgkmcnt(0)
    v_mfma_f32_16x16x32_bf16 v[96:99], v[32:35], v[48:51], v[96:99]
    ds_read_b128 v[80:83], v16 offset:0
    ds_read_b128 v[84:87], v16 offset:2048
    v_mfma_f32_16x16x32_bf16 v[100:103], v[32:35], v[52:55], v[100:103]
    ds_read_b64_tr_b16 v[64:65], v11 offset:8192
    ds_read_b64_tr_b16 v[66:67], v11 offset:9216
    v_mfma_f32_16x16x32_bf16 v[104:107], v[36:39], v[48:51], v[104:107]
    ds_read_b64_tr_b16 v[68:69], v12 offset:8192
    v_mfma_f32_16x16x32_bf16 v[108:111], v[36:39], v[52:55], v[108:111]
    ds_read_b64_tr_b16 v[70:71], v12 offset:9216
    v_mfma_f32_16x16x32_bf16 v[112:115], v[40:43], v[48:51], v[112:115]
    ds_read_b64_tr_b16 v[72:73], v13 offset:8192
    v_mfma_f32_16x16x32_bf16 v[116:119], v[40:43], v[52:55], v[116:119]
    ds_read_b64_tr_b16 v[74:75], v13 offset:9216
    v_mfma_f32_16x16x32_bf16 v[120:123], v[44:47], v[48:51], v[120:123]
    ds_read_b64_tr_b16 v[76:77], v14 offset:8192
    v_mfma_f32_16x16x32_bf16 v[124:127], v[44:47], v[52:55], v[124:127]
    ds_read_b64_tr_b16 v[78:79], v14 offset:9216
    s_waitcnt lgkmcnt(0)
    v_mfma_f32_16x16x32_bf16 v[96:99], v[64:67], v[80:83], v[96:99]
    v_mfma_f32_16x16x32_bf16 v[100:103], v[64:67], v[84:87], v[100:103]
    v_mfma_f32_16x16x32_bf16 v[104:107], v[68:71], v[80:83], v[104:107]
    v_mfma_f32_16x16x32_bf16 v[108:111], v[68:71], v[84:87], v[108:111]
    v_mfma_f32_16x16x32_bf16 v[112:115], v[72:75], v[80:83], v[112:115]
    v_mfma_f32_16x16x32_bf16 v[116:119], v[72:75], v[84:87], v[116:119]
    v_mfma_f32_16x16x32_bf16 v[120:123], v[76:79], v[80:83], v[120:123]
    v_mfma_f32_16x16x32_bf16 v[124:127], v[76:79], v[84:87], v[124:127]
    s_lshl_b32 s51, s7, 3
    s_lshl_b32 s52, s57, 1
    s_add_u32 s51, s51, s52
    s_mul_i32 s51, s51, 20
    s_lshl_b32 s52, s6, 2
    s_add_u32 s51, s51, s52
    s_lshl_b32 s52, s56, 1
    s_add_u32 s51, s51, s52
    s_lshl_b32 s54, s51, 10
    s_add_u32 s54, s54, 0
    s_add_u32 s55, s54, 20480
    v_lshlrev_b32 v62, 4, v0
    s_nop 7
    v_cvt_pk_bf16_f32 v32, v96, v97
    v_cvt_pk_bf16_f32 v33, v98, v99
    v_cvt_pk_bf16_f32 v34, v104, v105
    v_cvt_pk_bf16_f32 v35, v106, v107
    buffer_store_dwordx4 v[32:35], v62, s[16:19], s54 offen sc1
    v_cvt_pk_bf16_f32 v36, v112, v113
    v_cvt_pk_bf16_f32 v37, v114, v115
    v_cvt_pk_bf16_f32 v38, v120, v121
    v_cvt_pk_bf16_f32 v39, v122, v123
    buffer_store_dwordx4 v[36:39], v62, s[16:19], s54 offen offset:1024 sc1
    v_cvt_pk_bf16_f32 v40, v100, v101
    v_cvt_pk_bf16_f32 v41, v102, v103
    v_cvt_pk_bf16_f32 v42, v108, v109
    v_cvt_pk_bf16_f32 v43, v110, v111
    buffer_store_dwordx4 v[40:43], v62, s[16:19], s55 offen sc1
    v_cvt_pk_bf16_f32 v44, v116, v117
    v_cvt_pk_bf16_f32 v45, v118, v119
    v_cvt_pk_bf16_f32 v46, v124, v125
    v_cvt_pk_bf16_f32 v47, v126, v127
    buffer_store_dwordx4 v[44:47], v62, s[16:19], s55 offen offset:1024 sc1
    s_endpgm
P1_i:
    s_cmp_lg_u32 s3, 0
    s_cbranch_scc1 P1_end
    s_sub_u32 s24, s5, 30
IT_loop:
    s_mul_i32 s26, s24, 257
    s_lshr_b32 s26, s26, 10
    s_mul_i32 s51, s26, 4
    s_sub_u32 s51, s24, s51
    s_add_u32 s51, s51, 12
    s_add_u32 s26, s26, 8
    s_cmp_ge_u32 s51, 10
    s_cbranch_scc1 IT_tv
    s_lshl_b32 s51, s51, 6
    v_add_u32 v20, s51, v0
    v_lshrrev_b32 v21, 1, v20
    v_and_b32 v20, 1, v20
    s_mov_b32 s53, 6144
    v_mul_lo_u32 v21, v21, s53
    v_lshl_add_u32 v3, v20, 7, v21
    s_and_b32 s27, s4, 1
    s_mul_i32 s27, s27, 1966080
    s_lshl_b32 s52, s26, 8
    s_add_u32 s27, s27, s52
    s_mov_b32 s52, s34
    s_and_b32 s53, s35, 0xffff
    s_mov_b32 s54, 3932160
    s_mov_b32 s55, 0x00020000
    s_branch IT_td
IT_tv:
    s_sub_u32 s51, s51, 10
    s_lshl_b32 s51, s51, 6
    v_add_u32 v20, s51, v0
    v_mul_u32_u24 v21, 171, v20
    v_lshrrev_b32 v21, 10, v21
    v_mul_u32_u24 v22, 6, v21
    v_sub_u32 v20, v20, v22
    s_mov_b32 s53, 3072
    v_mul_lo_u32 v21, v21, s53
    v_lshl_add_u32 v3, v20, 7, v21
    s_lshr_b32 s27, s4, 1
    s_mul_i32 s27, s27, 768
    s_mul_i32 s52, s26, 196608
    s_add_u32 s27, s27, s52
    s_mov_b32 s52, s42
    s_and_b32 s53, s43, 0xffff
    s_mov_b32 s54, 4718592
    s_mov_b32 s55, 0x00020000
IT_td:
    buffer_load_dword v2, v3, s[52:55], s27 offen
    s_add_u32 s24, s24, 2
    s_cmp_lt_u32 s24, 64
    s_cbranch_scc1 IT_loop
    s_endpgm
P1_end:
    s_endpgm
.p2align 8
.type p2_kernel,@function
p2_kernel:
    s_cmp_ge_u32 s2, 256
    s_cbranch_scc1 P2_end
    s_load_dwordx2 s[44:45], s[0:1], 48
    s_load_dwordx2 s[48:49], s[0:1], 64
    v_lshrrev_b32 v1, 6, v0
    v_and_b32 v0, 63, v0
    s_and_b32 s4, s2, 7
    s_lshr_b32 s5, s2, 3
    v_readfirstlane_b32 s3, v1
    v_lshlrev_b32 v1, 4, v0
    s_and_b32 s6, s4, 3
    s_lshl_b32 s6, s6, 2
    s_and_b32 s51, s5, 3
    s_add_u32 s6, s6, s51
    s_lshr_b32 s7, s4, 2
    s_lshl_b32 s7, s7, 3
    s_lshr_b32 s51, s5, 2
    s_add_u32 s7, s7, s51
    s_cmp_ge_u32 s3, 4
    s_cbranch_scc0 P2_c
    s_sub_u32 s50, s3, 4
    s_and_b32 s51, s50, 1
    s_lshr_b32 s52, s50, 1
    s_mul_i32 s53, s52, 14336
    s_mul_i32 s55, s51, 3072
    s_add_u32 s54, s53, 6144
    s_add_u32 s53, s53, s55
    s_lshl_b32 s55, s51, 12
    s_add_u32 s54, s54, s55
    s_mul_i32 s55, s51, 3
    s_mul_i32 s56, s7, 6
    s_add_u32 s55, s55, s56
    s_mul_i32 s55, s55, 20
    s_add_u32 s55, s55, s52
    s_lshl_b32 s28, s55, 10
    s_add_u32 s28, s28, 2621440
    s_lshl_b32 s55, s51, 2
    s_lshl_b32 s56, s6, 3
    s_add_u32 s55, s55, s56
    s_mul_i32 s55, s55, 20
    s_add_u32 s55, s55, s52
    s_lshl_b32 s27, s55, 10
    s_add_u32 s27, s27, 0
    v_add_u32 v2, 19456, v1
    v_add_u32 v3, 38912, v1
    v_add_u32 v4, 58368, v1
    s_waitcnt lgkmcnt(0)
    s_mov_b32 s16, s48
    s_and_b32 s17, s49, 0xffff
    s_mov_b32 s18, 268435456
    s_mov_b32 s19, 0x00020000
    s_setprio 1
    s_mov_b32 s29, 0
    s_add_u32 m0, s29, s53
    s_nop 0
    buffer_load_dwordx4 v1, s[16:19], s28 offen lds
    buffer_load_dwordx4 v2, s[16:19], s28 offen offset:1024 lds
    buffer_load_dwordx4 v3, s[16:19], s28 offen offset:2048 lds
    s_add_u32 m0, s29, s54
    s_add_u32 s28, s28, 2048
    buffer_load_dwordx4 v1, s[16:19], s27 offen lds
    buffer_load_dwordx4 v2, s[16:19], s27 offen offset:1024 lds
    buffer_load_dwordx4 v3, s[16:19], s27 offen offset:2048 lds
    buffer_load_dwordx4 v4, s[16:19], s27 offen offset:3072 lds
    s_add_u32 s27, s27, 2048
    s_add_u32 s29, s29, 28672
    s_cmp_ge_u32 s29, 143360
    s_cselect_b32 s29, 0, s29
    s_add_u32 m0, s29, s53
    s_nop 0
    buffer_load_dwordx4 v1, s[16:19], s28 offen lds
    buffer_load_dwordx4 v2, s[16:19], s28 offen offset:1024 lds
    buffer_load_dwordx4 v3, s[16:19], s28 offen offset:2048 lds
    s_add_u32 m0, s29, s54
    s_add_u32 s28, s28, 2048
    buffer_load_dwordx4 v1, s[16:19], s27 offen lds
    buffer_load_dwordx4 v2, s[16:19], s27 offen offset:1024 lds
    buffer_load_dwordx4 v3, s[16:19], s27 offen offset:2048 lds
    buffer_load_dwordx4 v4, s[16:19], s27 offen offset:3072 lds
    s_add_u32 s27, s27, 2048
    s_add_u32 s29, s29, 28672
    s_cmp_ge_u32 s29, 143360
    s_cselect_b32 s29, 0, s29
    s_waitcnt vmcnt(7)
    s_barrier
    s_add_u32 m0, s29, s53
    s_nop 0
    buffer_load_dwordx4 v1, s[16:19], s28 offen lds
    buffer_load_dwordx4 v2, s[16:19], s28 offen offset:1024 lds
    buffer_load_dwordx4 v3, s[16:19], s28 offen offset:2048 lds
    s_add_u32 m0, s29, s54
    s_add_u32 s28, s28, 2048
    buffer_load_dwordx4 v1, s[16:19], s27 offen lds
    buffer_load_dwordx4 v2, s[16:19], s27 offen offset:1024 lds
    buffer_load_dwordx4 v3, s[16:19], s27 offen offset:2048 lds
    buffer_load_dwordx4 v4, s[16:19], s27 offen offset:3072 lds
    s_add_u32 s27, s27, 2048
    s_add_u32 s29, s29, 28672
    s_cmp_ge_u32 s29, 143360
    s_cselect_b32 s29, 0, s29
    s_add_u32 m0, s29, s53
    s_nop 0
    buffer_load_dwordx4 v1, s[16:19], s28 offen lds
    buffer_load_dwordx4 v2, s[16:19], s28 offen offset:1024 lds
    buffer_load_dwordx4 v3, s[16:19], s28 offen offset:2048 lds
    s_add_u32 m0, s29, s54
    s_add_u32 s28, s28, 2048
    buffer_load_dwordx4 v1, s[16:19], s27 offen lds
    buffer_load_dwordx4 v2, s[16:19], s27 offen offset:1024 lds
    buffer_load_dwordx4 v3, s[16:19], s27 offen offset:2048 lds
    buffer_load_dwordx4 v4, s[16:19], s27 offen offset:3072 lds
    s_add_u32 s27, s27, 2048
    s_add_u32 s29, s29, 28672
    s_cmp_ge_u32 s29, 143360
    s_cselect_b32 s29, 0, s29
    s_mov_b32 s31, 6
YL_ldloop:
    s_waitcnt vmcnt(14)
    s_barrier
    s_add_u32 m0, s29, s53
    s_nop 0
    buffer_load_dwordx4 v1, s[16:19], s28 offen lds
    buffer_load_dwordx4 v2, s[16:19], s28 offen offset:1024 lds
    buffer_load_dwordx4 v3, s[16:19], s28 offen offset:2048 lds
    s_add_u32 m0, s29, s54
    s_add_u32 s28, s28, 2048
    buffer_load_dwordx4 v1, s[16:19], s27 offen lds
    buffer_load_dwordx4 v2, s[16:19], s27 offen offset:1024 lds
    buffer_load_dwordx4 v3, s[16:19], s27 offen offset:2048 lds
    buffer_load_dwordx4 v4, s[16:19], s27 offen offset:3072 lds
    s_add_u32 s27, s27, 2048
    s_add_u32 s29, s29, 28672
    s_cmp_ge_u32 s29, 143360
    s_cselect_b32 s29, 0, s29
    s_sub_u32 s31, s31, 1
    s_cmp_lg_u32 s31, 0
    s_cbranch_scc1 YL_ldloop
    s_waitcnt vmcnt(14)
    s_barrier
    s_waitcnt vmcnt(7)
    s_barrier
    s_waitcnt vmcnt(0)
    s_barrier
    s_endpgm
P2_c:
    v_mov_b32 v64, 0
    v_mov_b32 v65, 0
    v_mov_b32 v66, 0
    v_mov_b32 v67, 0
    v_mov_b32 v68, 0
    v_mov_b32 v69, 0
    v_mov_b32 v70, 0
    v_mov_b32 v71, 0
    v_mov_b32 v72, 0
    v_mov_b32 v73, 0
    v_mov_b32 v74, 0
    v_mov_b32 v75, 0
    v_mov_b32 v76, 0
    v_mov_b32 v77, 0
    v_mov_b32 v78, 0
    v_mov_b32 v79, 0
    v_mov_b32 v80, 0
    v_mov_b32 v81, 0
    v_mov_b32 v82, 0
    v_mov_b32 v83, 0
    v_mov_b32 v84, 0
    v_mov_b32 v85, 0
    v_mov_b32 v86, 0
    v_mov_b32 v87, 0
    v_mov_b32 v88, 0
    v_mov_b32 v89, 0
    v_mov_b32 v90, 0
    v_mov_b32 v91, 0
    v_mov_b32 v92, 0
    v_mov_b32 v93, 0
    v_mov_b32 v94, 0
    v_mov_b32 v95, 0
    v_mov_b32 v96, 0
    v_mov_b32 v97, 0
    v_mov_b32 v98, 0
    v_mov_b32 v99, 0
    v_mov_b32 v100, 0
    v_mov_b32 v101, 0
    v_mov_b32 v102, 0
    v_mov_b32 v103, 0
    v_mov_b32 v104, 0
    v_mov_b32 v105, 0
    v_mov_b32 v106, 0
    v_mov_b32 v107, 0
    v_mov_b32 v108, 0
    v_mov_b32 v109, 0
    v_mov_b32 v110, 0
    v_mov_b32 v111, 0
    s_lshl_b32 s51, s3, 11
    s_add_u32 s51, s51, 6144
    v_add_u32 v2, s51, v1
    s_waitcnt lgkmcnt(0)
    s_mov_b32 s16, s48
    s_and_b32 s17, s49, 0xffff
    s_mov_b32 s18, 268435456
    s_mov_b32 s19, 0x00020000
    s_mov_b32 s8, s44
    s_and_b32 s9, s45, 0xffff
    s_mov_b32 s10, 6291456
    s_mov_b32 s11, 0x00020000
    s_mov_b32 s30, 0
    s_barrier
    v_add_u32 v3, s30, v1
    v_add_u32 v4, s30, v2
    s_add_u32 s30, s30, 28672
    s_cmp_ge_u32 s30, 143360
    s_cselect_b32 s30, 0, s30
    ds_read_b128 v[32:35], v4 offset:0
    ds_read_b128 v[36:39], v4 offset:1024
    ds_read_b128 v[8:11], v3 offset:0
    ds_read_b128 v[12:15], v3 offset:1024
    ds_read_b128 v[16:19], v3 offset:2048
    ds_read_b128 v[20:23], v3 offset:3072
    ds_read_b128 v[24:27], v3 offset:4096
    ds_read_b128 v[28:31], v3 offset:5120
    s_mov_b32 s31, 9
P2_loop:
    s_waitcnt lgkmcnt(0)
    v_mfma_f32_16x16x32_bf16 v[64:67], v[8:11], v[32:35], v[64:67]
    ds_read_b128 v[136:139], v4 offset:14336
    v_mfma_f32_16x16x32_bf16 v[68:71], v[8:11], v[36:39], v[68:71]
    ds_read_b128 v[140:143], v4 offset:15360
    v_mfma_f32_16x16x32_bf16 v[72:75], v[12:15], v[32:35], v[72:75]
    ds_read_b128 v[112:115], v3 offset:14336
    v_mfma_f32_16x16x32_bf16 v[76:79], v[12:15], v[36:39], v[76:79]
    ds_read_b128 v[116:119], v3 offset:15360
    v_mfma_f32_16x16x32_bf16 v[80:83], v[16:19], v[32:35], v[80:83]
    ds_read_b128 v[120:123], v3 offset:16384
    v_mfma_f32_16x16x32_bf16 v[84:87], v[16:19], v[36:39], v[84:87]
    ds_read_b128 v[124:127], v3 offset:17408
    v_mfma_f32_16x16x32_bf16 v[88:91], v[20:23], v[32:35], v[88:91]
    ds_read_b128 v[128:131], v3 offset:18432
    v_mfma_f32_16x16x32_bf16 v[92:95], v[20:23], v[36:39], v[92:95]
    ds_read_b128 v[132:135], v3 offset:19456
    v_mfma_f32_16x16x32_bf16 v[96:99], v[24:27], v[32:35], v[96:99]
    v_mfma_f32_16x16x32_bf16 v[100:103], v[24:27], v[36:39], v[100:103]
    v_mfma_f32_16x16x32_bf16 v[104:107], v[28:31], v[32:35], v[104:107]
    v_mfma_f32_16x16x32_bf16 v[108:111], v[28:31], v[36:39], v[108:111]
    s_waitcnt lgkmcnt(0)
    s_barrier
    v_add_u32 v3, s30, v1
    v_add_u32 v4, s30, v2
    s_add_u32 s30, s30, 28672
    s_cmp_ge_u32 s30, 143360
    s_cselect_b32 s30, 0, s30
    v_mfma_f32_16x16x32_bf16 v[64:67], v[112:115], v[136:139], v[64:67]
    ds_read_b128 v[32:35], v4 offset:0
    v_mfma_f32_16x16x32_bf16 v[68:71], v[112:115], v[140:143], v[68:71]
    ds_read_b128 v[36:39], v4 offset:1024
    v_mfma_f32_16x16x32_bf16 v[72:75], v[116:119], v[136:139], v[72:75]
    ds_read_b128 v[8:11], v3 offset:0
    v_mfma_f32_16x16x32_bf16 v[76:79], v[116:119], v[140:143], v[76:79]
    ds_read_b128 v[12:15], v3 offset:1024
    v_mfma_f32_16x16x32_bf16 v[80:83], v[120:123], v[136:139], v[80:83]
    ds_read_b128 v[16:19], v3 offset:2048
    v_mfma_f32_16x16x32_bf16 v[84:87], v[120:123], v[140:143], v[84:87]
    ds_read_b128 v[20:23], v3 offset:3072
    v_mfma_f32_16x16x32_bf16 v[88:91], v[124:127], v[136:139], v[88:91]
    ds_read_b128 v[24:27], v3 offset:4096
    v_mfma_f32_16x16x32_bf16 v[92:95], v[124:127], v[140:143], v[92:95]
    ds_read_b128 v[28:31], v3 offset:5120
    v_mfma_f32_16x16x32_bf16 v[96:99], v[128:131], v[136:139], v[96:99]
    v_mfma_f32_16x16x32_bf16 v[100:103], v[128:131], v[140:143], v[100:103]
    v_mfma_f32_16x16x32_bf16 v[104:107], v[132:135], v[136:139], v[104:107]
    v_mfma_f32_16x16x32_bf16 v[108:111], v[132:135], v[140:143], v[108:111]
    s_sub_u32 s31, s31, 1
    s_cmp_lg_u32 s31, 0
    s_cbranch_scc1 P2_loop
    s_waitcnt lgkmcnt(0)
    v_mfma_f32_16x16x32_bf16 v[64:67], v[8:11], v[32:35], v[64:67]
    ds_read_b128 v[136:139], v4 offset:14336
    v_mfma_f32_16x16x32_bf16 v[68:71], v[8:11], v[36:39], v[68:71]
    ds_read_b128 v[140:143], v4 offset:15360
    v_mfma_f32_16x16x32_bf16 v[72:75], v[12:15], v[32:35], v[72:75]
    ds_read_b128 v[112:115], v3 offset:14336
    v_mfma_f32_16x16x32_bf16 v[76:79], v[12:15], v[36:39], v[76:79]
    ds_read_b128 v[116:119], v3 offset:15360
    v_mfma_f32_16x16x32_bf16 v[80:83], v[16:19], v[32:35], v[80:83]
    ds_read_b128 v[120:123], v3 offset:16384
    v_mfma_f32_16x16x32_bf16 v[84:87], v[16:19], v[36:39], v[84:87]
    ds_read_b128 v[124:127], v3 offset:17408
    v_mfma_f32_16x16x32_bf16 v[88:91], v[20:23], v[32:35], v[88:91]
    ds_read_b128 v[128:131], v3 offset:18432
    v_mfma_f32_16x16x32_bf16 v[92:95], v[20:23], v[36:39], v[92:95]
    ds_read_b128 v[132:135], v3 offset:19456
    v_mfma_f32_16x16x32_bf16 v[96:99], v[24:27], v[32:35], v[96:99]
    v_mfma_f32_16x16x32_bf16 v[100:103], v[24:27], v[36:39], v[100:103]
    v_mfma_f32_16x16x32_bf16 v[104:107], v[28:31], v[32:35], v[104:107]
    v_mfma_f32_16x16x32_bf16 v[108:111], v[28:31], v[36:39], v[108:111]
    s_waitcnt lgkmcnt(0)
    v_mfma_f32_16x16x32_bf16 v[64:67], v[112:115], v[136:139], v[64:67]
    v_mfma_f32_16x16x32_bf16 v[68:71], v[112:115], v[140:143], v[68:71]
    v_mfma_f32_16x16x32_bf16 v[72:75], v[116:119], v[136:139], v[72:75]
    v_mfma_f32_16x16x32_bf16 v[76:79], v[116:119], v[140:143], v[76:79]
    v_mfma_f32_16x16x32_bf16 v[80:83], v[120:123], v[136:139], v[80:83]
    v_mfma_f32_16x16x32_bf16 v[84:87], v[120:123], v[140:143], v[84:87]
    v_mfma_f32_16x16x32_bf16 v[88:91], v[124:127], v[136:139], v[88:91]
    v_mfma_f32_16x16x32_bf16 v[92:95], v[124:127], v[140:143], v[92:95]
    v_mfma_f32_16x16x32_bf16 v[96:99], v[128:131], v[136:139], v[96:99]
    v_mfma_f32_16x16x32_bf16 v[100:103], v[128:131], v[140:143], v[100:103]
    v_mfma_f32_16x16x32_bf16 v[104:107], v[132:135], v[136:139], v[104:107]
    v_mfma_f32_16x16x32_bf16 v[108:111], v[132:135], v[140:143], v[108:111]
    v_and_b32 v3, 15, v0
    v_lshrrev_b32 v4, 4, v0
    s_mov_b32 s52, 3072
    v_mul_lo_u32 v3, v3, s52
    v_and_b32 v5, 1, v4
    v_lshrrev_b32 v4, 1, v4
    v_lshlrev_b32 v5, 5, v5
    v_lshl_add_u32 v5, v4, 4, v5
    v_add_u32 v3, v3, v5
    s_lshl_b32 s51, s6, 7
    s_lshl_b32 s52, s3, 5
    s_add_u32 s51, s51, s52
    s_mul_i32 s54, s51, 3072
    s_mul_i32 s52, s7, 192
    s_add_u32 s54, s54, s52
    s_add_u32 s55, s54, 49152
    s_nop 7
    v_cvt_pk_bf16_f32 v8, v64, v65
    v_cvt_pk_bf16_f32 v9, v66, v67
    v_cvt_pk_bf16_f32 v10, v72, v73
    v_cvt_pk_bf16_f32 v11, v74, v75
    s_nop 1
    v_permlane16_swap_b32 v8, v10
    v_permlane16_swap_b32 v9, v11
    s_nop 1
    buffer_store_dwordx4 v[8:11], v3, s[8:11], s54 offen sc1
    v_cvt_pk_bf16_f32 v12, v80, v81
    v_cvt_pk_bf16_f32 v13, v82, v83
    v_cvt_pk_bf16_f32 v14, v88, v89
    v_cvt_pk_bf16_f32 v15, v90, v91
    s_nop 1
    v_permlane16_swap_b32 v12, v14
    v_permlane16_swap_b32 v13, v15
    s_nop 1
    buffer_store_dwordx4 v[12:15], v3, s[8:11], s54 offen offset:64 sc1
    v_cvt_pk_bf16_f32 v16, v96, v97
    v_cvt_pk_bf16_f32 v17, v98, v99
    v_cvt_pk_bf16_f32 v18, v104, v105
    v_cvt_pk_bf16_f32 v19, v106, v107
    s_nop 1
    v_permlane16_swap_b32 v16, v18
    v_permlane16_swap_b32 v17, v19
    s_nop 1
    buffer_store_dwordx4 v[16:19], v3, s[8:11], s54 offen offset:128 sc1
    v_cvt_pk_bf16_f32 v20, v68, v69
    v_cvt_pk_bf16_f32 v21, v70, v71
    v_cvt_pk_bf16_f32 v22, v76, v77
    v_cvt_pk_bf16_f32 v23, v78, v79
    s_nop 1
    v_permlane16_swap_b32 v20, v22
    v_permlane16_swap_b32 v21, v23
    s_nop 1
    buffer_store_dwordx4 v[20:23], v3, s[8:11], s55 offen sc1
    v_cvt_pk_bf16_f32 v24, v84, v85
    v_cvt_pk_bf16_f32 v25, v86, v87
    v_cvt_pk_bf16_f32 v26, v92, v93
    v_cvt_pk_bf16_f32 v27, v94, v95
    s_nop 1
    v_permlane16_swap_b32 v24, v26
    v_permlane16_swap_b32 v25, v27
    s_nop 1
    buffer_store_dwordx4 v[24:27], v3, s[8:11], s55 offen offset:64 sc1
    v_cvt_pk_bf16_f32 v28, v100, v101
    v_cvt_pk_bf16_f32 v29, v102, v103
    v_cvt_pk_bf16_f32 v30, v108, v109
    v_cvt_pk_bf16_f32 v31, v110, v111
    s_nop 1
    v_permlane16_swap_b32 v28, v30
    v_permlane16_swap_b32 v29, v31
    s_nop 1
    buffer_store_dwordx4 v[28:31], v3, s[8:11], s55 offen offset:128 sc1
P2_end:
    s_endpgm
.section .rodata,"a"
.p2align 6
.amdhsa_kernel p1_kernel
  .amdhsa_next_free_vgpr 168
  .amdhsa_next_free_sgpr 96
  .amdhsa_accum_offset 168
  .amdhsa_group_segment_fixed_size 0
  .amdhsa_kernarg_size 72
  .amdhsa_user_sgpr_count 2
  .amdhsa_user_sgpr_kernarg_segment_ptr 1
  .amdhsa_system_sgpr_workgroup_id_x 1
  .amdhsa_float_denorm_mode_32 3
.end_amdhsa_kernel
.p2align 6
.amdhsa_kernel p2_kernel
  .amdhsa_next_free_vgpr 144
  .amdhsa_next_free_sgpr 96
  .amdhsa_accum_offset 144
  .amdhsa_group_segment_fixed_size 0
  .amdhsa_kernarg_size 72
  .amdhsa_user_sgpr_count 2
  .amdhsa_user_sgpr_kernarg_segment_ptr 1
  .amdhsa_system_sgpr_workgroup_id_x 1
  .amdhsa_float_denorm_mode_32 3
.end_amdhsa_kernel
```
